```python
import torch

def _softmax(x, axis=-1):
    return torch.softmax(x, dim=axis)
def _gelu(x):
    return torch.nn.functional.gelu(x, approximate="tanh")
def _silu(x):
    return torch.nn.functional.silu(x)
def _sigmoid(x):
    return torch.sigmoid(x)
def _layernorm(x, axis=-1, eps=1e-5):
    m = x.mean(dim=axis, keepdim=True)
    v = x.var(dim=axis, keepdim=True, unbiased=False)
    return (x - m) / torch.sqrt(v + eps)
def _scatter_add(tgt, idx, src, axis=0):
    return tgt.clone().index_add_(axis, idx, src)
def _segment_sum(src, seg, n):
    out = torch.zeros((n,) + src.shape[1:], dtype=src.dtype)
    return out.index_add_(0, seg, src)
def _pad(x, pw):
    flat = tuple(v for pair in reversed(pw) for v in pair)
    return torch.nn.functional.pad(x, flat)

kernel_name = 'standalone__gqa_block_cached__sampling'

def setup_inputs():

    _w = (lambda a: (lambda t: t.to(torch.bfloat16) if t.is_floating_point() else t)(torch.as_tensor(a)))
    B, Sq, D = 32, 8, 512
    Hq, Hkv, Sk, Dh = 32, 8, 2048, 128
    assert Hq % Hkv == 0, (Hq, Hkv)
    return {
        "x": _w((lambda *s: torch.randn(*s, dtype=torch.bfloat16) * 0.8)(B, Sq, D)),
        "k_cache": _w((lambda *s: torch.randn(*s, dtype=torch.bfloat16) * 0.8)(B, Hkv, Sk, Dh)),
        "v_cache": _w((lambda *s: torch.randn(*s, dtype=torch.bfloat16) * 0.05)(B, Hkv, Sk, Dh)),
        "wq": _w((lambda *s: torch.randn(*s, dtype=torch.bfloat16) * 0.8)(D, Hq * Dh) * (D ** -0.5)),
        "wo": _w((lambda *s: torch.randn(*s, dtype=torch.bfloat16) * 0.05)(Hq * Dh, D) * ((Hq * Dh) ** -0.5)),
    }

def reference(x, k_cache, v_cache, wq, wo):
    B, Sq, D = x.shape
    Hq, Dh = 32, 128
    Hkv = k_cache.shape[1]
    rep = Hq // Hkv
    q = (lambda x, *d: x.permute(*d))((x @ wq).reshape(B, Sq, Hq, Dh), 0, 2, 1, 3)
    k = (lambda x, n, axis: torch.repeat_interleave(x, n, dim=axis))(k_cache, rep, axis=1)
    v = (lambda x, n, axis: torch.repeat_interleave(x, n, dim=axis))(v_cache, rep, axis=1)
    scores = torch.einsum("bhqd,bhkd->bhqk", q, k) * (Dh ** -0.5)
    p = _softmax(scores, axis=-1)
    o = torch.einsum("bhqk,bhkd->bhqd", p, v)
    return (lambda x, *d: x.permute(*d))(o, 0, 2, 1, 3).reshape(B, Sq, Hq * Dh) @ wo
```

```asm
; @launch grid=(256,1,1) block=(512,1,1) lds=149056
.amdgcn_target "amdgcn-amd-amdhsa--gfx950"
.text
.globl standalone__gqa_block_cached__sampling_kernel
.p2align 8
.type standalone__gqa_block_cached__sampling_kernel,@function
standalone__gqa_block_cached__sampling_kernel:
  s_cmp_ge_u32 s2, 256
  s_cbranch_scc1 L_end
  s_load_dwordx16 s[4:19], s[0:1], 0
  s_memrealtime s[62:63]
  v_mov_b32 v2, 148992
  v_mov_b32 v3, 0
  ds_write_b32 v2, v3 offset:0
  ds_write_b32 v2, v3 offset:4
  ds_write_b32 v2, v3 offset:8
  ds_write_b32 v2, v3 offset:12
  ds_write_b32 v2, v3 offset:16
  ds_write_b32 v2, v3 offset:20
  ds_write_b32 v2, v3 offset:24
  ds_write_b32 v2, v3 offset:28
  v_lshrrev_b32 v1, 6, v0
  v_and_b32 v0, 63, v0
  v_readfirstlane_b32 s20, v1
  s_and_b32 s21, s2, 7
  s_lshr_b32 s22, s2, 3
  s_mov_b32 s40, 0x05040100
  s_mov_b32 s41, 0x07060302
  v_lshrrev_b32 v2, 4, v0
  v_and_b32 v3, 15, v0
  v_lshlrev_b32 v2, 13, v2
  v_lshlrev_b32 v4, 4, v3
  v_add_u32 v252, v2, v4
  v_and_b32 v2, 15, v0
  v_mul_u32_u24 v2, 544, v2
  v_lshrrev_b32 v3, 4, v0
  v_lshlrev_b32 v3, 4, v3
  v_add_u32 v2, v2, v3
  v_add_u32 v253, 139264, v2
  s_and_b32 s23, s20, 3
  s_waitcnt lgkmcnt(0)
  s_sub_u32 s60, s62, 2048
  s_xor_b32 s61, s62, 0x9e3779b9
  s_lshl_b32 s34, s21, 19
  s_lshl_b32 s38, s23, 8
  s_add_u32 s34, s34, s38
  s_add_u32 s44, s12, s34
  s_addc_u32 s45, s13, 0
  s_and_b32 s45, s45, 0xffff
  s_sub_u32 s46, 524288, s38
  s_mov_b32 s47, 0x20000
  s_barrier
  s_cmp_ge_u32 s20, 4
  s_cbranch_scc1 L_pwave
  s_mov_b32 s3, 0
  s_lshl_b32 s34, s2, 19
  s_add_u32 s24, s6, s34
  s_addc_u32 s25, s7, 0
  s_and_b32 s25, s25, 0xffff
  s_mov_b32 s26, 524288
  s_mov_b32 s27, 0x20000
  s_add_u32 s28, s8, s34
  s_addc_u32 s29, s9, 0
  s_and_b32 s29, s29, 0xffff
  s_mov_b32 s30, 524288
  s_mov_b32 s31, 0x20000
  s_lshl_b32 s32, s20, 15
  s_mul_i32 s33, s20, 1024
  s_mov_b32 s36, 0x3e0293ee
  v_lshrrev_b32 v1, 4, v0
  v_and_b32 v2, 15, v0
  v_lshlrev_b32 v3, 8, v1
  v_xor_b32 v4, v2, v1
  v_xor_b32 v5, 0, v4
  v_lshlrev_b32 v5, 4, v5
  v_add_u32 v20, v3, v5
  v_xor_b32 v5, 4, v4
  v_lshlrev_b32 v5, 4, v5
  v_add_u32 v21, v3, v5
  v_xor_b32 v5, 8, v4
  v_lshlrev_b32 v5, 4, v5
  v_add_u32 v22, v3, v5
  v_xor_b32 v5, 12, v4
  v_lshlrev_b32 v5, 4, v5
  v_add_u32 v23, v3, v5
  v_lshlrev_b32 v5, 2, v1
  v_xor_b32 v5, v5, v2
  v_lshlrev_b32 v5, 4, v5
  v_add_u32 v24, v3, v5
  s_add_u32 m0, s32, 0
  s_add_u32 s34, s33, 0
  buffer_load_dwordx4 v20, s[24:27], s34 offen nt lds
  s_add_u32 m0, s32, 1024
  s_add_u32 s34, s33, 4096
  buffer_load_dwordx4 v21, s[24:27], s34 offen nt lds
  s_add_u32 m0, s32, 2048
  s_add_u32 s34, s33, 8192
  buffer_load_dwordx4 v22, s[24:27], s34 offen nt lds
  s_add_u32 m0, s32, 3072
  s_add_u32 s34, s33, 12288
  buffer_load_dwordx4 v23, s[24:27], s34 offen nt lds
  s_add_u32 m0, s32, 4096
  s_add_u32 s34, s33, 16384
  buffer_load_dwordx4 v20, s[24:27], s34 offen nt lds
  s_add_u32 m0, s32, 5120
  s_add_u32 s34, s33, 20480
  buffer_load_dwordx4 v21, s[24:27], s34 offen nt lds
  s_waitcnt vmcnt(5)
  s_add_u32 m0, s32, 6144
  s_add_u32 s34, s33, 24576
  buffer_load_dwordx4 v22, s[24:27], s34 offen nt lds
  s_waitcnt vmcnt(5)
  s_add_u32 m0, s32, 7168
  s_add_u32 s34, s33, 28672
  buffer_load_dwordx4 v23, s[24:27], s34 offen nt lds
  v_and_b32 v1, 31, v0
  v_lshrrev_b32 v2, 5, v0
  v_and_b32 v3, 15, v1
  v_xor_b32 v3, v3, v2
  v_lshlrev_b32 v4, 8, v1
  v_add_u32 v4, s32, v4
  v_xor_b32 v5, 0, v3
  v_lshlrev_b32 v5, 4, v5
  v_add_u32 v8, v4, v5
  v_xor_b32 v5, 2, v3
  v_lshlrev_b32 v5, 4, v5
  v_add_u32 v9, v4, v5
  v_xor_b32 v5, 4, v3
  v_lshlrev_b32 v5, 4, v5
  v_add_u32 v10, v4, v5
  v_xor_b32 v5, 6, v3
  v_lshlrev_b32 v5, 4, v5
  v_add_u32 v11, v4, v5
  v_xor_b32 v5, 8, v3
  v_lshlrev_b32 v5, 4, v5
  v_add_u32 v12, v4, v5
  v_xor_b32 v5, 10, v3
  v_lshlrev_b32 v5, 4, v5
  v_add_u32 v13, v4, v5
  v_xor_b32 v5, 12, v3
  v_lshlrev_b32 v5, 4, v5
  v_add_u32 v14, v4, v5
  v_xor_b32 v5, 14, v3
  v_lshlrev_b32 v5, 4, v5
  v_add_u32 v15, v4, v5
  v_lshrrev_b32 v1, 4, v0
  v_lshrrev_b32 v2, 2, v0
  v_and_b32 v2, 3, v2
  v_and_b32 v3, 3, v0
  v_lshrrev_b32 v4, 1, v1
  v_lshlrev_b32 v4, 2, v4
  v_add_u32 v4, v4, v2
  v_lshlrev_b32 v4, 8, v4
  v_and_b32 v5, 1, v1
  v_lshlrev_b32 v5, 5, v5
  v_add_u32 v4, v4, v5
  v_lshlrev_b32 v5, 3, v3
  v_add_u32 v4, v4, v5
  v_add_u32 v4, s32, v4
  v_add_u32 v4, 8192, v4
  v_xor_b32 v5, 0, v2
  v_lshlrev_b32 v5, 6, v5
  v_add_u32 v16, v4, v5
  v_xor_b32 v5, 1, v2
  v_lshlrev_b32 v5, 6, v5
  v_add_u32 v17, v4, v5
  v_xor_b32 v5, 2, v2
  v_lshlrev_b32 v5, 6, v5
  v_add_u32 v18, v4, v5
  v_xor_b32 v5, 3, v2
  v_lshlrev_b32 v5, 6, v5
  v_add_u32 v19, v4, v5
  v_mov_b32 v25, 0xff800000
  v_mov_b32 v26, 0
  v_mov_b32 v124, 0
  v_mov_b32 v125, 0
  v_mov_b32 v126, 0
  v_mov_b32 v127, 0
  v_mov_b32 v128, 0
  v_mov_b32 v129, 0
  v_mov_b32 v130, 0
  v_mov_b32 v131, 0
  v_mov_b32 v132, 0
  v_mov_b32 v133, 0
  v_mov_b32 v134, 0
  v_mov_b32 v135, 0
  v_mov_b32 v136, 0
  v_mov_b32 v137, 0
  v_mov_b32 v138, 0
  v_mov_b32 v139, 0
  v_mov_b32 v140, 0
  v_mov_b32 v141, 0
  v_mov_b32 v142, 0
  v_mov_b32 v143, 0
  v_mov_b32 v144, 0
  v_mov_b32 v145, 0
  v_mov_b32 v146, 0
  v_mov_b32 v147, 0
  v_mov_b32 v148, 0
  v_mov_b32 v149, 0
  v_mov_b32 v150, 0
  v_mov_b32 v151, 0
  v_mov_b32 v152, 0
  v_mov_b32 v153, 0
  v_mov_b32 v154, 0
  v_mov_b32 v155, 0
  v_mov_b32 v156, 0
  v_mov_b32 v157, 0
  v_mov_b32 v158, 0
  v_mov_b32 v159, 0
  v_mov_b32 v160, 0
  v_mov_b32 v161, 0
  v_mov_b32 v162, 0
  v_mov_b32 v163, 0
  v_mov_b32 v164, 0
  v_mov_b32 v165, 0
  v_mov_b32 v166, 0
  v_mov_b32 v167, 0
  v_mov_b32 v168, 0
  v_mov_b32 v169, 0
  v_mov_b32 v170, 0
  v_mov_b32 v171, 0
  v_mov_b32 v172, 0
  v_mov_b32 v173, 0
  v_mov_b32 v174, 0
  v_mov_b32 v175, 0
  v_mov_b32 v176, 0
  v_mov_b32 v177, 0
  v_mov_b32 v178, 0
  v_mov_b32 v179, 0
  v_mov_b32 v180, 0
  v_mov_b32 v181, 0
  v_mov_b32 v182, 0
  v_mov_b32 v183, 0
  v_mov_b32 v184, 0
  v_mov_b32 v185, 0
  v_mov_b32 v186, 0
  v_mov_b32 v187, 0
  v_lshlrev_b32 v254, 4, v0
  v_add_u32 v254, s32, v254
  s_waitcnt vmcnt(5)
  s_add_u32 m0, s32, 8192
  s_add_u32 s34, s33, 0
  buffer_load_dwordx4 v24, s[28:31], s34 offen nt lds
  s_waitcnt vmcnt(5)
  s_add_u32 m0, s32, 9216
  s_add_u32 s34, s33, 4096
  buffer_load_dwordx4 v24, s[28:31], s34 offen nt lds
  s_waitcnt vmcnt(5)
  s_add_u32 m0, s32, 10240
  s_add_u32 s34, s33, 8192
  buffer_load_dwordx4 v24, s[28:31], s34 offen nt lds
  s_waitcnt vmcnt(5)
  s_add_u32 m0, s32, 11264
  s_add_u32 s34, s33, 12288
  buffer_load_dwordx4 v24, s[28:31], s34 offen nt lds
  s_waitcnt vmcnt(5)
  s_add_u32 m0, s32, 12288
  s_add_u32 s34, s33, 16384
  buffer_load_dwordx4 v24, s[28:31], s34 offen nt lds
  s_waitcnt vmcnt(5)
  s_add_u32 m0, s32, 13312
  s_add_u32 s34, s33, 20480
  buffer_load_dwordx4 v24, s[28:31], s34 offen nt lds
  s_waitcnt vmcnt(5)
  s_add_u32 m0, s32, 14336
  s_add_u32 s34, s33, 24576
  buffer_load_dwordx4 v24, s[28:31], s34 offen nt lds
  s_waitcnt vmcnt(5)
  s_add_u32 m0, s32, 15360
  s_add_u32 s34, s33, 28672
  buffer_load_dwordx4 v24, s[28:31], s34 offen nt lds
  s_waitcnt vmcnt(5)
  s_add_u32 m0, s32, 16384
  s_add_u32 s34, s33, 32768
  buffer_load_dwordx4 v20, s[24:27], s34 offen nt lds
  s_waitcnt vmcnt(5)
  s_add_u32 m0, s32, 17408
  s_add_u32 s34, s33, 36864
  buffer_load_dwordx4 v21, s[24:27], s34 offen nt lds
  s_waitcnt vmcnt(5)
  s_add_u32 m0, s32, 18432
  s_add_u32 s34, s33, 40960
  buffer_load_dwordx4 v22, s[24:27], s34 offen nt lds
  s_waitcnt vmcnt(5)
  s_add_u32 m0, s32, 19456
  s_add_u32 s34, s33, 45056
  buffer_load_dwordx4 v23, s[24:27], s34 offen nt lds
  s_waitcnt vmcnt(5)
  s_add_u32 m0, s32, 20480
  s_add_u32 s34, s33, 49152
  buffer_load_dwordx4 v20, s[24:27], s34 offen nt lds
  s_waitcnt vmcnt(5)
  s_add_u32 m0, s32, 21504
  s_add_u32 s34, s33, 53248
  buffer_load_dwordx4 v21, s[24:27], s34 offen nt lds
  s_waitcnt vmcnt(5)
  s_add_u32 m0, s32, 22528
  s_add_u32 s34, s33, 57344
  buffer_load_dwordx4 v22, s[24:27], s34 offen nt lds
  s_waitcnt vmcnt(5)
  s_add_u32 m0, s32, 23552
  s_add_u32 s34, s33, 61440
  buffer_load_dwordx4 v23, s[24:27], s34 offen nt lds
  v_mov_b32 v6, 148992
L_spin_1:
  ds_read_b32 v7, v6 offset:4
  s_waitcnt lgkmcnt(0)
  v_readfirstlane_b32 s34, v7
  s_cmp_ge_u32 s34, 2
  s_cbranch_scc0 L_spin_1
  s_waitcnt vmcnt(5)
  s_add_u32 m0, s32, 24576
  s_add_u32 s34, s33, 32768
  buffer_load_dwordx4 v24, s[28:31], s34 offen nt lds
  s_waitcnt vmcnt(5)
  s_add_u32 m0, s32, 25600
  s_add_u32 s34, s33, 36864
  buffer_load_dwordx4 v24, s[28:31], s34 offen nt lds
  s_waitcnt vmcnt(5)
  s_add_u32 m0, s32, 26624
  s_add_u32 s34, s33, 40960
  buffer_load_dwordx4 v24, s[28:31], s34 offen nt lds
  s_waitcnt vmcnt(5)
  s_add_u32 m0, s32, 27648
  s_add_u32 s34, s33, 45056
  buffer_load_dwordx4 v24, s[28:31], s34 offen nt lds
  s_waitcnt vmcnt(5)
  s_add_u32 m0, s32, 28672
  s_add_u32 s34, s33, 49152
  buffer_load_dwordx4 v24, s[28:31], s34 offen nt lds
  s_waitcnt vmcnt(5)
  s_add_u32 m0, s32, 29696
  s_add_u32 s34, s33, 53248
  buffer_load_dwordx4 v24, s[28:31], s34 offen nt lds
  s_waitcnt vmcnt(5)
  s_add_u32 m0, s32, 30720
  s_add_u32 s34, s33, 57344
  buffer_load_dwordx4 v24, s[28:31], s34 offen nt lds
  s_waitcnt vmcnt(5)
  s_add_u32 m0, s32, 31744
  s_add_u32 s34, s33, 61440
  buffer_load_dwordx4 v24, s[28:31], s34 offen nt lds
  s_waitcnt vmcnt(5)
  s_add_u32 s34, s33, 65536
  buffer_load_dwordx4 v[188:191], v20, s[24:27], s34 offen nt
  s_waitcnt vmcnt(5)
  s_add_u32 s34, s33, 69632
  buffer_load_dwordx4 v[192:195], v21, s[24:27], s34 offen nt
  s_waitcnt vmcnt(5)
  s_add_u32 s34, s33, 73728
  buffer_load_dwordx4 v[196:199], v22, s[24:27], s34 offen nt
  s_waitcnt vmcnt(5)
  s_add_u32 s34, s33, 77824
  buffer_load_dwordx4 v[200:203], v23, s[24:27], s34 offen nt
  s_waitcnt vmcnt(5)
  s_add_u32 s34, s33, 81920
  buffer_load_dwordx4 v[204:207], v20, s[24:27], s34 offen nt
  s_waitcnt vmcnt(5)
  s_add_u32 s34, s33, 86016
  buffer_load_dwordx4 v[208:211], v21, s[24:27], s34 offen nt
  s_barrier
  s_sub_u32 s34, 131072, s32
  v_add_u32 v1, s34, v8
  ds_read_b128 v[60:63], v1
  v_add_u32 v1, s34, v9
  ds_read_b128 v[64:67], v1
  v_add_u32 v1, s34, v10
  ds_read_b128 v[68:71], v1
  v_add_u32 v1, s34, v11
  ds_read_b128 v[72:75], v1
  v_add_u32 v1, s34, v12
  ds_read_b128 v[76:79], v1
  v_add_u32 v1, s34, v13
  ds_read_b128 v[80:83], v1
  v_add_u32 v1, s34, v14
  ds_read_b128 v[84:87], v1
  v_add_u32 v1, s34, v15
  ds_read_b128 v[88:91], v1
  s_waitcnt lgkmcnt(0)
  ds_read_b128 v[92:95], v8 offset:0
  ds_read_b128 v[96:99], v9 offset:0
  ds_read_b128 v[100:103], v10 offset:0
  ds_read_b128 v[104:107], v11 offset:0
  ds_read_b128 v[108:111], v12 offset:0
  ds_read_b128 v[112:115], v13 offset:0
  ds_read_b128 v[116:119], v14 offset:0
  ds_read_b128 v[120:123], v15 offset:0
  s_waitcnt lgkmcnt(4)
  v_mfma_f32_32x32x16_bf16 v[44:59], v[92:95], v[60:63], 0
  v_mfma_f32_32x32x16_bf16 v[44:59], v[96:99], v[64:67], v[44:59]
  v_mfma_f32_32x32x16_bf16 v[44:59], v[100:103], v[68:71], v[44:59]
  v_mfma_f32_32x32x16_bf16 v[44:59], v[104:107], v[72:75], v[44:59]
  s_waitcnt lgkmcnt(0)
  v_mfma_f32_32x32x16_bf16 v[44:59], v[108:111], v[76:79], v[44:59]
  v_mfma_f32_32x32x16_bf16 v[44:59], v[112:115], v[80:83], v[44:59]
  v_mfma_f32_32x32x16_bf16 v[44:59], v[116:119], v[84:87], v[44:59]
  v_mfma_f32_32x32x16_bf16 v[44:59], v[120:123], v[88:91], v[44:59]
  ds_read_b64_tr_b16 v[92:93], v16 offset:0
  ds_read_b64_tr_b16 v[94:95], v16 offset:2048
  ds_read_b64_tr_b16 v[96:97], v17 offset:0
  ds_read_b64_tr_b16 v[98:99], v17 offset:2048
  ds_read_b64_tr_b16 v[100:101], v18 offset:0
  ds_read_b64_tr_b16 v[102:103], v18 offset:2048
  ds_read_b64_tr_b16 v[104:105], v19 offset:0
  ds_read_b64_tr_b16 v[106:107], v19 offset:2048
  ds_read_b64_tr_b16 v[108:109], v16 offset:4096
  ds_read_b64_tr_b16 v[110:111], v16 offset:6144
  ds_read_b64_tr_b16 v[112:113], v17 offset:4096
  ds_read_b64_tr_b16 v[114:115], v17 offset:6144
  ds_read_b64_tr_b16 v[116:117], v18 offset:4096
  ds_read_b64_tr_b16 v[118:119], v18 offset:6144
  ds_read_b64_tr_b16 v[120:121], v19 offset:4096
  ds_read_b64_tr_b16 v[122:123], v19 offset:6144
  v_max3_f32 v29, v44, v45, v46
  v_max3_f32 v30, v47, v48, v49
  v_max3_f32 v31, v50, v51, v52
  v_max3_f32 v32, v53, v54, v55
  v_max3_f32 v33, v56, v57, v58
  v_max3_f32 v29, v29, v30, v59
  v_max3_f32 v31, v31, v32, v33
  v_max_f32 v29, v29, v31
  v_mov_b32 v30, v29
  s_nop 1
  v_permlane32_swap_b32 v29, v30
  s_nop 1
  s_waitcnt vmcnt(5)
  s_add_u32 m0, s32, 6144
  s_add_u32 s34, s33, 90112
  buffer_load_dwordx4 v22, s[24:27], s34 offen nt lds
  v_max3_f32 v29, v29, v30, v25
  v_mul_f32 v27, s36, v29
  v_fma_f32 v28, v25, s36, -v27
  v_mov_b32 v25, v29
  v_exp_f32 v28, v28
  v_fma_f32 v44, v44, s36, -v27
  v_fma_f32 v45, v45, s36, -v27
  v_fma_f32 v46, v46, s36, -v27
  v_fma_f32 v47, v47, s36, -v27
  v_fma_f32 v48, v48, s36, -v27
  v_fma_f32 v49, v49, s36, -v27
  v_fma_f32 v50, v50, s36, -v27
  v_fma_f32 v51, v51, s36, -v27
  s_waitcnt vmcnt(5)
  s_add_u32 m0, s32, 7168
  s_add_u32 s34, s33, 94208
  buffer_load_dwordx4 v23, s[24:27], s34 offen nt lds
  v_fma_f32 v52, v52, s36, -v27
  v_fma_f32 v53, v53, s36, -v27
  v_fma_f32 v54, v54, s36, -v27
  v_fma_f32 v55, v55, s36, -v27
  v_fma_f32 v56, v56, s36, -v27
  v_fma_f32 v57, v57, s36, -v27
  v_fma_f32 v58, v58, s36, -v27
  v_fma_f32 v59, v59, s36, -v27
  v_exp_f32 v44, v44
  v_exp_f32 v45, v45
  v_exp_f32 v46, v46
  v_exp_f32 v47, v47
  s_waitcnt lgkmcnt(0)
  s_waitcnt vmcnt(5)
  s_add_u32 m0, s32, 8192
  s_add_u32 s34, s33, 65536
  buffer_load_dwordx4 v24, s[28:31], s34 offen nt lds
  v_exp_f32 v48, v48
  v_exp_f32 v49, v49
  v_exp_f32 v50, v50
  v_exp_f32 v51, v51
  v_exp_f32 v52, v52
  v_exp_f32 v53, v53
  v_exp_f32 v54, v54
  v_exp_f32 v55, v55
  v_exp_f32 v56, v56
  v_exp_f32 v57, v57
  v_exp_f32 v58, v58
  v_exp_f32 v59, v59
  v_mul_f32 v26, v26, v28
  s_waitcnt vmcnt(5)
  s_add_u32 m0, s32, 9216
  s_add_u32 s34, s33, 69632
  buffer_load_dwordx4 v24, s[28:31], s34 offen nt lds
  v_add_f32 v29, v44, v48
  v_add_f32 v30, v45, v49
  v_add_f32 v31, v46, v50
  v_add_f32 v32, v47, v51
  v_add_f32 v29, v29, v52
  v_add_f32 v30, v30, v53
  v_add_f32 v31, v31, v54
  v_add_f32 v32, v32, v55
  v_add_f32 v29, v29, v56
  v_add_f32 v30, v30, v57
  v_add_f32 v31, v31, v58
  v_add_f32 v32, v32, v59
  s_waitcnt vmcnt(5)
  s_add_u32 m0, s32, 10240
  s_add_u32 s34, s33, 73728
  buffer_load_dwordx4 v24, s[28:31], s34 offen nt lds
  v_add_f32 v29, v29, v30
  v_add_f32 v31, v31, v32
  v_cvt_pk_bf16_f32 v36, v44, v45
  v_cvt_pk_bf16_f32 v37, v46, v47
  v_cvt_pk_bf16_f32 v38, v48, v49
  v_cvt_pk_bf16_f32 v39, v50, v51
  v_cvt_pk_bf16_f32 v40, v52, v53
  v_cvt_pk_bf16_f32 v41, v54, v55
  v_cvt_pk_bf16_f32 v42, v56, v57
  v_cvt_pk_bf16_f32 v43, v58, v59
  v_add_f32 v26, v26, v29
  v_add_f32 v26, v26, v31
  v_mul_f32 v124, v124, v28
  s_waitcnt vmcnt(5)
  s_add_u32 m0, s32, 11264
  s_add_u32 s34, s33, 77824
  buffer_load_dwordx4 v24, s[28:31], s34 offen nt lds
  v_mul_f32 v125, v125, v28
  v_mul_f32 v126, v126, v28
  v_mul_f32 v127, v127, v28
  v_mul_f32 v128, v128, v28
  v_mul_f32 v129, v129, v28
  v_mul_f32 v130, v130, v28
  v_mul_f32 v131, v131, v28
  v_mul_f32 v132, v132, v28
  v_mul_f32 v133, v133, v28
  v_mul_f32 v134, v134, v28
  v_mul_f32 v135, v135, v28
  v_mul_f32 v136, v136, v28
  s_waitcnt vmcnt(5)
  s_add_u32 m0, s32, 12288
  s_add_u32 s34, s33, 81920
  buffer_load_dwordx4 v24, s[28:31], s34 offen nt lds
  v_mul_f32 v137, v137, v28
  v_mul_f32 v138, v138, v28
  v_mul_f32 v139, v139, v28
  v_mul_f32 v140, v140, v28
  v_mul_f32 v141, v141, v28
  v_mul_f32 v142, v142, v28
  v_mul_f32 v143, v143, v28
  v_mul_f32 v144, v144, v28
  v_mul_f32 v145, v145, v28
  v_mul_f32 v146, v146, v28
  v_mul_f32 v147, v147, v28
  v_mul_f32 v148, v148, v28
  v_mul_f32 v149, v149, v28
  s_waitcnt vmcnt(5)
  s_add_u32 m0, s32, 13312
  s_add_u32 s34, s33, 86016
  buffer_load_dwordx4 v24, s[28:31], s34 offen nt lds
  v_mul_f32 v150, v150, v28
  v_mul_f32 v151, v151, v28
  v_mul_f32 v152, v152, v28
  v_mul_f32 v153, v153, v28
  v_mul_f32 v154, v154, v28
  v_mul_f32 v155, v155, v28
  v_mul_f32 v156, v156, v28
  v_mul_f32 v157, v157, v28
  v_mul_f32 v158, v158, v28
  v_mul_f32 v159, v159, v28
  v_mul_f32 v160, v160, v28
  v_mul_f32 v161, v161, v28
  s_waitcnt vmcnt(5)
  s_add_u32 m0, s32, 14336
  s_add_u32 s34, s33, 90112
  buffer_load_dwordx4 v24, s[28:31], s34 offen nt lds
  v_mul_f32 v162, v162, v28
  v_mul_f32 v163, v163, v28
  v_mul_f32 v164, v164, v28
  v_mul_f32 v165, v165, v28
  v_mul_f32 v166, v166, v28
  v_mul_f32 v167, v167, v28
  v_mul_f32 v168, v168, v28
  v_mul_f32 v169, v169, v28
  v_mul_f32 v170, v170, v28
  v_mul_f32 v171, v171, v28
  v_mul_f32 v172, v172, v28
  v_mul_f32 v173, v173, v28
  v_mul_f32 v174, v174, v28
  s_waitcnt vmcnt(5)
  s_add_u32 m0, s32, 15360
  s_add_u32 s34, s33, 94208
  buffer_load_dwordx4 v24, s[28:31], s34 offen nt lds
  v_mul_f32 v175, v175, v28
  v_mul_f32 v176, v176, v28
  v_mul_f32 v177, v177, v28
  v_mul_f32 v178, v178, v28
  v_mul_f32 v179, v179, v28
  v_mul_f32 v180, v180, v28
  v_mul_f32 v181, v181, v28
  v_mul_f32 v182, v182, v28
  v_mul_f32 v183, v183, v28
  v_mul_f32 v184, v184, v28
  v_mul_f32 v185, v185, v28
  v_mul_f32 v186, v186, v28
  v_mul_f32 v187, v187, v28
  s_waitcnt lgkmcnt(0)
  ds_write_b128 v254, v[188:191] offset:0
  ds_write_b128 v254, v[192:195] offset:1024
  ds_write_b128 v254, v[196:199] offset:2048
  ds_write_b128 v254, v[200:203] offset:3072
  ds_write_b128 v254, v[204:207] offset:4096
  ds_write_b128 v254, v[208:211] offset:5120
  v_mfma_f32_32x32x16_bf16 v[124:139], v[92:95], v[36:39], v[124:139]
  v_mfma_f32_32x32x16_bf16 v[140:155], v[96:99], v[36:39], v[140:155]
  v_mfma_f32_32x32x16_bf16 v[156:171], v[100:103], v[36:39], v[156:171]
  v_mfma_f32_32x32x16_bf16 v[172:187], v[104:107], v[36:39], v[172:187]
  v_mfma_f32_32x32x16_bf16 v[124:139], v[108:111], v[40:43], v[124:139]
  v_mfma_f32_32x32x16_bf16 v[140:155], v[112:115], v[40:43], v[140:155]
  v_mfma_f32_32x32x16_bf16 v[156:171], v[116:119], v[40:43], v[156:171]
  v_mfma_f32_32x32x16_bf16 v[172:187], v[120:123], v[40:43], v[172:187]
  v_mov_b32 v6, 148992
  v_mov_b32 v7, 1
  s_mov_b32 exec_lo, 1
  s_mov_b32 exec_hi, 0
  ds_add_u32 v6, v7 offset:20
  s_mov_b64 exec, -1
  ds_read_b128 v[92:95], v8 offset:16384
  ds_read_b128 v[96:99], v9 offset:16384
  ds_read_b128 v[100:103], v10 offset:16384
  ds_read_b128 v[104:107], v11 offset:16384
  ds_read_b128 v[108:111], v12 offset:16384
  ds_read_b128 v[112:115], v13 offset:16384
  ds_read_b128 v[116:119], v14 offset:16384
  ds_read_b128 v[120:123], v15 offset:16384
  s_waitcnt lgkmcnt(4)
  v_mfma_f32_32x32x16_bf16 v[44:59], v[92:95], v[60:63], 0
  v_mfma_f32_32x32x16_bf16 v[44:59], v[96:99], v[64:67], v[44:59]
  v_mfma_f32_32x32x16_bf16 v[44:59], v[100:103], v[68:71], v[44:59]
  v_mfma_f32_32x32x16_bf16 v[44:59], v[104:107], v[72:75], v[44:59]
  s_waitcnt lgkmcnt(0)
  v_mfma_f32_32x32x16_bf16 v[44:59], v[108:111], v[76:79], v[44:59]
  v_mfma_f32_32x32x16_bf16 v[44:59], v[112:115], v[80:83], v[44:59]
  v_mfma_f32_32x32x16_bf16 v[44:59], v[116:119], v[84:87], v[44:59]
  v_mfma_f32_32x32x16_bf16 v[44:59], v[120:123], v[88:91], v[44:59]
  ds_read_b64_tr_b16 v[92:93], v16 offset:16384
  ds_read_b64_tr_b16 v[94:95], v16 offset:18432
  ds_read_b64_tr_b16 v[96:97], v17 offset:16384
  ds_read_b64_tr_b16 v[98:99], v17 offset:18432
  ds_read_b64_tr_b16 v[100:101], v18 offset:16384
  ds_read_b64_tr_b16 v[102:103], v18 offset:18432
  ds_read_b64_tr_b16 v[104:105], v19 offset:16384
  ds_read_b64_tr_b16 v[106:107], v19 offset:18432
  ds_read_b64_tr_b16 v[108:109], v16 offset:20480
  ds_read_b64_tr_b16 v[110:111], v16 offset:22528
  ds_read_b64_tr_b16 v[112:113], v17 offset:20480
  ds_read_b64_tr_b16 v[114:115], v17 offset:22528
  ds_read_b64_tr_b16 v[116:117], v18 offset:20480
  ds_read_b64_tr_b16 v[118:119], v18 offset:22528
  ds_read_b64_tr_b16 v[120:121], v19 offset:20480
  ds_read_b64_tr_b16 v[122:123], v19 offset:22528
  v_max3_f32 v29, v44, v45, v46
  v_max3_f32 v30, v47, v48, v49
  v_max3_f32 v31, v50, v51, v52
  v_max3_f32 v32, v53, v54, v55
  v_max3_f32 v33, v56, v57, v58
  s_waitcnt vmcnt(5)
  s_add_u32 m0, s32, 16384
  s_add_u32 s34, s33, 98304
  buffer_load_dwordx4 v20, s[24:27], s34 offen nt lds
  v_max3_f32 v29, v29, v30, v59
  v_max3_f32 v31, v31, v32, v33
  v_max_f32 v29, v29, v31
  v_mov_b32 v30, v29
  s_nop 1
  v_permlane32_swap_b32 v29, v30
  s_mov_b32 s34, 196608
  buffer_load_dwordx4 v[188:191], v252, s[44:47], s34 offen offset:0
  s_nop 1
  v_max3_f32 v29, v29, v30, v25
  v_mul_f32 v27, s36, v29
  v_fma_f32 v28, v25, s36, -v27
  v_mov_b32 v25, v29
  s_mov_b32 s34, 196608
  buffer_load_dwordx4 v[196:199], v252, s[44:47], s34 offen offset:1024
  v_exp_f32 v28, v28
  v_fma_f32 v44, v44, s36, -v27
  v_fma_f32 v45, v45, s36, -v27
  v_fma_f32 v46, v46, s36, -v27
  v_fma_f32 v47, v47, s36, -v27
  v_fma_f32 v48, v48, s36, -v27
  s_waitcnt vmcnt(7)
  s_add_u32 m0, s32, 17408
  s_add_u32 s34, s33, 102400
  buffer_load_dwordx4 v21, s[24:27], s34 offen nt lds
  v_fma_f32 v49, v49, s36, -v27
  v_fma_f32 v50, v50, s36, -v27
  v_fma_f32 v51, v51, s36, -v27
  v_fma_f32 v52, v52, s36, -v27
  v_fma_f32 v53, v53, s36, -v27
  s_mov_b32 s34, 196608
  buffer_load_dwordx4 v[204:207], v252, s[44:47], s34 offen offset:2048
  v_fma_f32 v54, v54, s36, -v27
  v_fma_f32 v55, v55, s36, -v27
  v_fma_f32 v56, v56, s36, -v27
  v_fma_f32 v57, v57, s36, -v27
  v_fma_f32 v58, v58, s36, -v27
  v_fma_f32 v59, v59, s36, -v27
  s_mov_b32 s34, 196608
  buffer_load_dwordx4 v[212:215], v252, s[44:47], s34 offen offset:3072
  v_exp_f32 v44, v44
  v_exp_f32 v45, v45
  v_exp_f32 v46, v46
  v_exp_f32 v47, v47
  v_exp_f32 v48, v48
  s_waitcnt vmcnt(9)
  s_add_u32 m0, s32, 18432
  s_add_u32 s34, s33, 106496
  buffer_load_dwordx4 v22, s[24:27], s34 offen nt lds
  v_exp_f32 v49, v49
  v_exp_f32 v50, v50
  v_exp_f32 v51, v51
  v_exp_f32 v52, v52
  v_exp_f32 v53, v53
  v_exp_f32 v54, v54
  s_mov_b32 s34, 200704
  buffer_load_dwordx4 v[220:223], v252, s[44:47], s34 offen offset:0
  v_exp_f32 v55, v55
  v_exp_f32 v56, v56
  v_exp_f32 v57, v57
  v_exp_f32 v58, v58
  v_exp_f32 v59, v59
  s_mov_b32 s34, 200704
  buffer_load_dwordx4 v[228:231], v252, s[44:47], s34 offen offset:1024
  v_mul_f32 v26, v26, v28
  v_add_f32 v29, v44, v48
  v_add_f32 v30, v45, v49
  v_add_f32 v31, v46, v50
  v_add_f32 v32, v47, v51
  v_add_f32 v29, v29, v52
  s_waitcnt vmcnt(11)
  s_add_u32 m0, s32, 19456
  s_add_u32 s34, s33, 110592
  buffer_load_dwordx4 v23, s[24:27], s34 offen nt lds
  v_add_f32 v30, v30, v53
  v_add_f32 v31, v31, v54
  v_add_f32 v32, v32, v55
  v_add_f32 v29, v29, v56
  v_add_f32 v30, v30, v57
  s_mov_b32 s34, 200704
  buffer_load_dwordx4 v[236:239], v252, s[44:47], s34 offen offset:2048
  v_add_f32 v31, v31, v58
  v_add_f32 v32, v32, v59
  v_add_f32 v29, v29, v30
  v_add_f32 v31, v31, v32
  v_cvt_pk_bf16_f32 v36, v44, v45
  v_cvt_pk_bf16_f32 v37, v46, v47
  s_mov_b32 s34, 200704
  buffer_load_dwordx4 v[244:247], v252, s[44:47], s34 offen offset:3072
  v_cvt_pk_bf16_f32 v38, v48, v49
  v_cvt_pk_bf16_f32 v39, v50, v51
  v_cvt_pk_bf16_f32 v40, v52, v53
  v_cvt_pk_bf16_f32 v41, v54, v55
  v_cvt_pk_bf16_f32 v42, v56, v57
  s_waitcnt vmcnt(13)
  s_add_u32 m0, s32, 20480
  s_add_u32 s34, s33, 114688
  buffer_load_dwordx4 v20, s[24:27], s34 offen nt lds
  v_cvt_pk_bf16_f32 v43, v58, v59
  v_add_f32 v26, v26, v29
  v_add_f32 v26, v26, v31
  v_mul_f32 v124, v124, v28
  v_mul_f32 v125, v125, v28
  v_mul_f32 v126, v126, v28
  s_mov_b32 s34, 229376
  buffer_load_dwordx4 v[192:195], v252, s[44:47], s34 offen offset:0
  v_mul_f32 v127, v127, v28
  v_mul_f32 v128, v128, v28
  v_mul_f32 v129, v129, v28
  v_mul_f32 v130, v130, v28
  v_mul_f32 v131, v131, v28
  s_mov_b32 s34, 229376
  buffer_load_dwordx4 v[200:203], v252, s[44:47], s34 offen offset:1024
  v_mul_f32 v132, v132, v28
  v_mul_f32 v133, v133, v28
  v_mul_f32 v134, v134, v28
  v_mul_f32 v135, v135, v28
  v_mul_f32 v136, v136, v28
  v_mul_f32 v137, v137, v28
  s_waitcnt vmcnt(15)
  s_add_u32 m0, s32, 21504
  s_add_u32 s34, s33, 118784
  buffer_load_dwordx4 v21, s[24:27], s34 offen nt lds
  v_mul_f32 v138, v138, v28
  v_mul_f32 v139, v139, v28
  v_mul_f32 v140, v140, v28
  v_mul_f32 v141, v141, v28
  v_mul_f32 v142, v142, v28
  s_mov_b32 s34, 229376
  buffer_load_dwordx4 v[208:211], v252, s[44:47], s34 offen offset:2048
  v_mul_f32 v143, v143, v28
  v_mul_f32 v144, v144, v28
  v_mul_f32 v145, v145, v28
  v_mul_f32 v146, v146, v28
  v_mul_f32 v147, v147, v28
  v_mul_f32 v148, v148, v28
  s_mov_b32 s34, 229376
  buffer_load_dwordx4 v[216:219], v252, s[44:47], s34 offen offset:3072
  v_mul_f32 v149, v149, v28
  v_mul_f32 v150, v150, v28
  v_mul_f32 v151, v151, v28
  v_mul_f32 v152, v152, v28
  v_mul_f32 v153, v153, v28
  s_waitcnt vmcnt(17)
  s_add_u32 m0, s32, 22528
  s_add_u32 s34, s33, 122880
  buffer_load_dwordx4 v22, s[24:27], s34 offen nt lds
  v_mul_f32 v154, v154, v28
  v_mul_f32 v155, v155, v28
  v_mul_f32 v156, v156, v28
  v_mul_f32 v157, v157, v28
  v_mul_f32 v158, v158, v28
  v_mul_f32 v159, v159, v28
  s_mov_b32 s34, 233472
  buffer_load_dwordx4 v[224:227], v252, s[44:47], s34 offen offset:0
  v_mul_f32 v160, v160, v28
  v_mul_f32 v161, v161, v28
  v_mul_f32 v162, v162, v28
  v_mul_f32 v163, v163, v28
  v_mul_f32 v164, v164, v28
  s_mov_b32 s34, 233472
  buffer_load_dwordx4 v[232:235], v252, s[44:47], s34 offen offset:1024
  v_mul_f32 v165, v165, v28
  v_mul_f32 v166, v166, v28
  v_mul_f32 v167, v167, v28
  v_mul_f32 v168, v168, v28
  v_mul_f32 v169, v169, v28
  v_mul_f32 v170, v170, v28
  s_waitcnt vmcnt(17)
  s_add_u32 m0, s32, 23552
  s_add_u32 s34, s33, 126976
  buffer_load_dwordx4 v23, s[24:27], s34 offen nt lds
  v_mul_f32 v171, v171, v28
  v_mul_f32 v172, v172, v28
  v_mul_f32 v173, v173, v28
  v_mul_f32 v174, v174, v28
  v_mul_f32 v175, v175, v28
  s_mov_b32 s34, 233472
  buffer_load_dwordx4 v[240:243], v252, s[44:47], s34 offen offset:2048
  v_mul_f32 v176, v176, v28
  v_mul_f32 v177, v177, v28
  v_mul_f32 v178, v178, v28
  v_mul_f32 v179, v179, v28
  v_mul_f32 v180, v180, v28
  v_mul_f32 v181, v181, v28
  s_mov_b32 s34, 233472
  buffer_load_dwordx4 v[248:251], v252, s[44:47], s34 offen offset:3072
  v_mul_f32 v182, v182, v28
  v_mul_f32 v183, v183, v28
  v_mul_f32 v184, v184, v28
  v_mul_f32 v185, v185, v28
  v_mul_f32 v186, v186, v28
  v_mul_f32 v187, v187, v28
  s_waitcnt lgkmcnt(0)
  v_mfma_f32_32x32x16_bf16 v[124:139], v[92:95], v[36:39], v[124:139]
  s_waitcnt vmcnt(17)
  s_add_u32 m0, s32, 24576
  s_add_u32 s34, s33, 98304
  buffer_load_dwordx4 v24, s[28:31], s34 offen nt lds
  v_mfma_f32_32x32x16_bf16 v[140:155], v[96:99], v[36:39], v[140:155]
  s_waitcnt vmcnt(15)
  s_add_u32 m0, s32, 25600
  s_add_u32 s34, s33, 102400
  buffer_load_dwordx4 v24, s[28:31], s34 offen nt lds
  v_mfma_f32_32x32x16_bf16 v[156:171], v[100:103], v[36:39], v[156:171]
  s_waitcnt vmcnt(13)
  s_add_u32 m0, s32, 26624
  s_add_u32 s34, s33, 106496
  buffer_load_dwordx4 v24, s[28:31], s34 offen nt lds
  v_mfma_f32_32x32x16_bf16 v[172:187], v[104:107], v[36:39], v[172:187]
  s_waitcnt vmcnt(11)
  s_add_u32 m0, s32, 27648
  s_add_u32 s34, s33, 110592
  buffer_load_dwordx4 v24, s[28:31], s34 offen nt lds
  v_mfma_f32_32x32x16_bf16 v[124:139], v[108:111], v[40:43], v[124:139]
  s_waitcnt vmcnt(9)
  s_add_u32 m0, s32, 28672
  s_add_u32 s34, s33, 114688
  buffer_load_dwordx4 v24, s[28:31], s34 offen nt lds
  v_mfma_f32_32x32x16_bf16 v[140:155], v[112:115], v[40:43], v[140:155]
  s_waitcnt vmcnt(7)
  s_add_u32 m0, s32, 29696
  s_add_u32 s34, s33, 118784
  buffer_load_dwordx4 v24, s[28:31], s34 offen nt lds
  v_mfma_f32_32x32x16_bf16 v[156:171], v[116:119], v[40:43], v[156:171]
  s_waitcnt vmcnt(5)
  s_add_u32 m0, s32, 30720
  s_add_u32 s34, s33, 122880
  buffer_load_dwordx4 v24, s[28:31], s34 offen nt lds
  v_mfma_f32_32x32x16_bf16 v[172:187], v[120:123], v[40:43], v[172:187]
  s_waitcnt vmcnt(5)
  s_add_u32 m0, s32, 31744
  s_add_u32 s34, s33, 126976
  buffer_load_dwordx4 v24, s[28:31], s34 offen nt lds
  s_add_u32 s33, s33, 131072
  s_mov_b32 s35, 5
L_loop:
  ds_read_b128 v[92:95], v8 offset:0
  ds_read_b128 v[96:99], v9 offset:0
  ds_read_b128 v[100:103], v10 offset:0
  ds_read_b128 v[104:107], v11 offset:0
  ds_read_b128 v[108:111], v12 offset:0
  ds_read_b128 v[112:115], v13 offset:0
  ds_read_b128 v[116:119], v14 offset:0
  ds_read_b128 v[120:123], v15 offset:0
  s_waitcnt lgkmcnt(4)
  v_mfma_f32_32x32x16_bf16 v[44:59], v[92:95], v[60:63], 0
  v_mfma_f32_32x32x16_bf16 v[44:59], v[96:99], v[64:67], v[44:59]
  v_mfma_f32_32x32x16_bf16 v[44:59], v[100:103], v[68:71], v[44:59]
  v_mfma_f32_32x32x16_bf16 v[44:59], v[104:107], v[72:75], v[44:59]
  s_waitcnt lgkmcnt(0)
  v_mfma_f32_32x32x16_bf16 v[44:59], v[108:111], v[76:79], v[44:59]
  v_mfma_f32_32x32x16_bf16 v[44:59], v[112:115], v[80:83], v[44:59]
  v_mfma_f32_32x32x16_bf16 v[44:59], v[116:119], v[84:87], v[44:59]
  v_mfma_f32_32x32x16_bf16 v[44:59], v[120:123], v[88:91], v[44:59]
  ds_read_b64_tr_b16 v[92:93], v16 offset:0
  ds_read_b64_tr_b16 v[94:95], v16 offset:2048
  ds_read_b64_tr_b16 v[96:97], v17 offset:0
  ds_read_b64_tr_b16 v[98:99], v17 offset:2048
  ds_read_b64_tr_b16 v[100:101], v18 offset:0
  ds_read_b64_tr_b16 v[102:103], v18 offset:2048
  ds_read_b64_tr_b16 v[104:105], v19 offset:0
  ds_read_b64_tr_b16 v[106:107], v19 offset:2048
  ds_read_b64_tr_b16 v[108:109], v16 offset:4096
  ds_read_b64_tr_b16 v[110:111], v16 offset:6144
  ds_read_b64_tr_b16 v[112:113], v17 offset:4096
  ds_read_b64_tr_b16 v[114:115], v17 offset:6144
  ds_read_b64_tr_b16 v[116:117], v18 offset:4096
  ds_read_b64_tr_b16 v[118:119], v18 offset:6144
  ds_read_b64_tr_b16 v[120:121], v19 offset:4096
  ds_read_b64_tr_b16 v[122:123], v19 offset:6144
  v_max3_f32 v29, v44, v45, v46
  v_max3_f32 v30, v47, v48, v49
  v_max3_f32 v31, v50, v51, v52
  v_max3_f32 v32, v53, v54, v55
  v_max3_f32 v33, v56, v57, v58
  v_max3_f32 v29, v29, v30, v59
  v_max3_f32 v31, v31, v32, v33
  v_max_f32 v29, v29, v31
  v_mov_b32 v30, v29
  s_nop 1
  v_permlane32_swap_b32 v29, v30
  s_nop 1
  v_max3_f32 v29, v29, v30, v25
  v_mul_f32 v27, s36, v29
  v_fma_f32 v28, v25, s36, -v27
  s_waitcnt vmcnt(5)
  s_add_u32 m0, s32, 0
  s_add_u32 s34, s33, 0
  buffer_load_dwordx4 v20, s[24:27], s34 offen nt lds
  v_mov_b32 v25, v29
  v_exp_f32 v28, v28
  v_fma_f32 v44, v44, s36, -v27
  v_fma_f32 v45, v45, s36, -v27
  v_fma_f32 v46, v46, s36, -v27
  v_fma_f32 v47, v47, s36, -v27
  v_fma_f32 v48, v48, s36, -v27
  v_fma_f32 v49, v49, s36, -v27
  v_fma_f32 v50, v50, s36, -v27
  v_fma_f32 v51, v51, s36, -v27
  v_fma_f32 v52, v52, s36, -v27
  v_fma_f32 v53, v53, s36, -v27
  v_fma_f32 v54, v54, s36, -v27
  v_fma_f32 v55, v55, s36, -v27
  v_fma_f32 v56, v56, s36, -v27
  s_waitcnt vmcnt(5)
  s_add_u32 m0, s32, 1024
  s_add_u32 s34, s33, 4096
  buffer_load_dwordx4 v21, s[24:27], s34 offen nt lds
  v_fma_f32 v57, v57, s36, -v27
  v_fma_f32 v58, v58, s36, -v27
  v_fma_f32 v59, v59, s36, -v27
  v_exp_f32 v44, v44
  v_exp_f32 v45, v45
  v_exp_f32 v46, v46
  v_exp_f32 v47, v47
  v_exp_f32 v48, v48
  v_exp_f32 v49, v49
  v_exp_f32 v50, v50
  v_exp_f32 v51, v51
  v_exp_f32 v52, v52
  v_exp_f32 v53, v53
  v_exp_f32 v54, v54
  v_exp_f32 v55, v55
  v_exp_f32 v56, v56
  s_waitcnt vmcnt(5)
  s_add_u32 m0, s32, 2048
  s_add_u32 s34, s33, 8192
  buffer_load_dwordx4 v22, s[24:27], s34 offen nt lds
  v_exp_f32 v57, v57
  v_exp_f32 v58, v58
  v_exp_f32 v59, v59
  v_mul_f32 v26, v26, v28
  v_add_f32 v29, v44, v48
  v_add_f32 v30, v45, v49
  v_add_f32 v31, v46, v50
  v_add_f32 v32, v47, v51
  v_add_f32 v29, v29, v52
  v_add_f32 v30, v30, v53
  v_add_f32 v31, v31, v54
  v_add_f32 v32, v32, v55
  v_add_f32 v29, v29, v56
  v_add_f32 v30, v30, v57
  v_add_f32 v31, v31, v58
  s_waitcnt vmcnt(5)
  s_add_u32 m0, s32, 3072
  s_add_u32 s34, s33, 12288
  buffer_load_dwordx4 v23, s[24:27], s34 offen nt lds
  v_add_f32 v32, v32, v59
  v_add_f32 v29, v29, v30
  v_add_f32 v31, v31, v32
  v_cvt_pk_bf16_f32 v36, v44, v45
  v_cvt_pk_bf16_f32 v37, v46, v47
  v_cvt_pk_bf16_f32 v38, v48, v49
  v_cvt_pk_bf16_f32 v39, v50, v51
  v_cvt_pk_bf16_f32 v40, v52, v53
  v_cvt_pk_bf16_f32 v41, v54, v55
  v_cvt_pk_bf16_f32 v42, v56, v57
  v_cvt_pk_bf16_f32 v43, v58, v59
  v_add_f32 v26, v26, v29
  v_add_f32 v26, v26, v31
  v_mul_f32 v124, v124, v28
  v_mul_f32 v125, v125, v28
  s_waitcnt vmcnt(5)
  s_add_u32 m0, s32, 4096
  s_add_u32 s34, s33, 16384
  buffer_load_dwordx4 v20, s[24:27], s34 offen nt lds
  v_mul_f32 v126, v126, v28
  v_mul_f32 v127, v127, v28
  v_mul_f32 v128, v128, v28
  v_mul_f32 v129, v129, v28
  v_mul_f32 v130, v130, v28
  v_mul_f32 v131, v131, v28
  v_mul_f32 v132, v132, v28
  v_mul_f32 v133, v133, v28
  v_mul_f32 v134, v134, v28
  v_mul_f32 v135, v135, v28
  v_mul_f32 v136, v136, v28
  v_mul_f32 v137, v137, v28
  v_mul_f32 v138, v138, v28
  v_mul_f32 v139, v139, v28
  v_mul_f32 v140, v140, v28
  v_mul_f32 v141, v141, v28
  s_waitcnt vmcnt(5)
  s_add_u32 m0, s32, 5120
  s_add_u32 s34, s33, 20480
  buffer_load_dwordx4 v21, s[24:27], s34 offen nt lds
  v_mul_f32 v142, v142, v28
  v_mul_f32 v143, v143, v28
  v_mul_f32 v144, v144, v28
  v_mul_f32 v145, v145, v28
  v_mul_f32 v146, v146, v28
  v_mul_f32 v147, v147, v28
  v_mul_f32 v148, v148, v28
  v_mul_f32 v149, v149, v28
  v_mul_f32 v150, v150, v28
  v_mul_f32 v151, v151, v28
  v_mul_f32 v152, v152, v28
  v_mul_f32 v153, v153, v28
  v_mul_f32 v154, v154, v28
  v_mul_f32 v155, v155, v28
  v_mul_f32 v156, v156, v28
  s_waitcnt vmcnt(5)
  s_add_u32 m0, s32, 6144
  s_add_u32 s34, s33, 24576
  buffer_load_dwordx4 v22, s[24:27], s34 offen nt lds
  v_mul_f32 v157, v157, v28
  v_mul_f32 v158, v158, v28
  v_mul_f32 v159, v159, v28
  v_mul_f32 v160, v160, v28
  v_mul_f32 v161, v161, v28
  v_mul_f32 v162, v162, v28
  v_mul_f32 v163, v163, v28
  v_mul_f32 v164, v164, v28
  v_mul_f32 v165, v165, v28
  v_mul_f32 v166, v166, v28
  v_mul_f32 v167, v167, v28
  v_mul_f32 v168, v168, v28
  v_mul_f32 v169, v169, v28
  v_mul_f32 v170, v170, v28
  v_mul_f32 v171, v171, v28
  s_waitcnt vmcnt(5)
  s_add_u32 m0, s32, 7168
  s_add_u32 s34, s33, 28672
  buffer_load_dwordx4 v23, s[24:27], s34 offen nt lds
  v_mul_f32 v172, v172, v28
  v_mul_f32 v173, v173, v28
  v_mul_f32 v174, v174, v28
  v_mul_f32 v175, v175, v28
  v_mul_f32 v176, v176, v28
  v_mul_f32 v177, v177, v28
  v_mul_f32 v178, v178, v28
  v_mul_f32 v179, v179, v28
  v_mul_f32 v180, v180, v28
  v_mul_f32 v181, v181, v28
  v_mul_f32 v182, v182, v28
  v_mul_f32 v183, v183, v28
  v_mul_f32 v184, v184, v28
  v_mul_f32 v185, v185, v28
  v_mul_f32 v186, v186, v28
  v_mul_f32 v187, v187, v28
  s_waitcnt lgkmcnt(0)
  v_mfma_f32_32x32x16_bf16 v[124:139], v[92:95], v[36:39], v[124:139]
  s_waitcnt vmcnt(5)
  s_add_u32 m0, s32, 8192
  s_add_u32 s34, s33, 0
  buffer_load_dwordx4 v24, s[28:31], s34 offen nt lds
  v_mfma_f32_32x32x16_bf16 v[140:155], v[96:99], v[36:39], v[140:155]
  s_waitcnt vmcnt(5)
  s_add_u32 m0, s32, 9216
  s_add_u32 s34, s33, 4096
  buffer_load_dwordx4 v24, s[28:31], s34 offen nt lds
  v_mfma_f32_32x32x16_bf16 v[156:171], v[100:103], v[36:39], v[156:171]
  s_waitcnt vmcnt(5)
  s_add_u32 m0, s32, 10240
  s_add_u32 s34, s33, 8192
  buffer_load_dwordx4 v24, s[28:31], s34 offen nt lds
  v_mfma_f32_32x32x16_bf16 v[172:187], v[104:107], v[36:39], v[172:187]
  s_waitcnt vmcnt(5)
  s_add_u32 m0, s32, 11264
  s_add_u32 s34, s33, 12288
  buffer_load_dwordx4 v24, s[28:31], s34 offen nt lds
  v_mfma_f32_32x32x16_bf16 v[124:139], v[108:111], v[40:43], v[124:139]
  s_waitcnt vmcnt(5)
  s_add_u32 m0, s32, 12288
  s_add_u32 s34, s33, 16384
  buffer_load_dwordx4 v24, s[28:31], s34 offen nt lds
  v_mfma_f32_32x32x16_bf16 v[140:155], v[112:115], v[40:43], v[140:155]
  s_waitcnt vmcnt(5)
  s_add_u32 m0, s32, 13312
  s_add_u32 s34, s33, 20480
  buffer_load_dwordx4 v24, s[28:31], s34 offen nt lds
  v_mfma_f32_32x32x16_bf16 v[156:171], v[116:119], v[40:43], v[156:171]
  s_waitcnt vmcnt(5)
  s_add_u32 m0, s32, 14336
  s_add_u32 s34, s33, 24576
  buffer_load_dwordx4 v24, s[28:31], s34 offen nt lds
  v_mfma_f32_32x32x16_bf16 v[172:187], v[120:123], v[40:43], v[172:187]
  s_waitcnt vmcnt(5)
  s_add_u32 m0, s32, 15360
  s_add_u32 s34, s33, 28672
  buffer_load_dwordx4 v24, s[28:31], s34 offen nt lds
  s_add_u32 s33, s33, 32768
  ds_read_b128 v[92:95], v8 offset:16384
  ds_read_b128 v[96:99], v9 offset:16384
  ds_read_b128 v[100:103], v10 offset:16384
  ds_read_b128 v[104:107], v11 offset:16384
  ds_read_b128 v[108:111], v12 offset:16384
  ds_read_b128 v[112:115], v13 offset:16384
  ds_read_b128 v[116:119], v14 offset:16384
  ds_read_b128 v[120:123], v15 offset:16384
  s_waitcnt lgkmcnt(4)
  v_mfma_f32_32x32x16_bf16 v[44:59], v[92:95], v[60:63], 0
  v_mfma_f32_32x32x16_bf16 v[44:59], v[96:99], v[64:67], v[44:59]
  v_mfma_f32_32x32x16_bf16 v[44:59], v[100:103], v[68:71], v[44:59]
  v_mfma_f32_32x32x16_bf16 v[44:59], v[104:107], v[72:75], v[44:59]
  s_waitcnt lgkmcnt(0)
  v_mfma_f32_32x32x16_bf16 v[44:59], v[108:111], v[76:79], v[44:59]
  v_mfma_f32_32x32x16_bf16 v[44:59], v[112:115], v[80:83], v[44:59]
  v_mfma_f32_32x32x16_bf16 v[44:59], v[116:119], v[84:87], v[44:59]
  v_mfma_f32_32x32x16_bf16 v[44:59], v[120:123], v[88:91], v[44:59]
  ds_read_b64_tr_b16 v[92:93], v16 offset:16384
  ds_read_b64_tr_b16 v[94:95], v16 offset:18432
  ds_read_b64_tr_b16 v[96:97], v17 offset:16384
  ds_read_b64_tr_b16 v[98:99], v17 offset:18432
  ds_read_b64_tr_b16 v[100:101], v18 offset:16384
  ds_read_b64_tr_b16 v[102:103], v18 offset:18432
  ds_read_b64_tr_b16 v[104:105], v19 offset:16384
  ds_read_b64_tr_b16 v[106:107], v19 offset:18432
  ds_read_b64_tr_b16 v[108:109], v16 offset:20480
  ds_read_b64_tr_b16 v[110:111], v16 offset:22528
  ds_read_b64_tr_b16 v[112:113], v17 offset:20480
  ds_read_b64_tr_b16 v[114:115], v17 offset:22528
  ds_read_b64_tr_b16 v[116:117], v18 offset:20480
  ds_read_b64_tr_b16 v[118:119], v18 offset:22528
  ds_read_b64_tr_b16 v[120:121], v19 offset:20480
  ds_read_b64_tr_b16 v[122:123], v19 offset:22528
  v_max3_f32 v29, v44, v45, v46
  v_max3_f32 v30, v47, v48, v49
  v_max3_f32 v31, v50, v51, v52
  v_max3_f32 v32, v53, v54, v55
  v_max3_f32 v33, v56, v57, v58
  v_max3_f32 v29, v29, v30, v59
  v_max3_f32 v31, v31, v32, v33
  v_max_f32 v29, v29, v31
  v_mov_b32 v30, v29
  s_nop 1
  v_permlane32_swap_b32 v29, v30
  s_nop 1
  v_max3_f32 v29, v29, v30, v25
  v_mul_f32 v27, s36, v29
  v_fma_f32 v28, v25, s36, -v27
  s_waitcnt vmcnt(5)
  s_add_u32 m0, s32, 16384
  s_add_u32 s34, s33, 0
  buffer_load_dwordx4 v20, s[24:27], s34 offen nt lds
  v_mov_b32 v25, v29
  v_exp_f32 v28, v28
  v_fma_f32 v44, v44, s36, -v27
  v_fma_f32 v45, v45, s36, -v27
  v_fma_f32 v46, v46, s36, -v27
  v_fma_f32 v47, v47, s36, -v27
  v_fma_f32 v48, v48, s36, -v27
  v_fma_f32 v49, v49, s36, -v27
  v_fma_f32 v50, v50, s36, -v27
  v_fma_f32 v51, v51, s36, -v27
  v_fma_f32 v52, v52, s36, -v27
  v_fma_f32 v53, v53, s36, -v27
  v_fma_f32 v54, v54, s36, -v27
  v_fma_f32 v55, v55, s36, -v27
  v_fma_f32 v56, v56, s36, -v27
  s_waitcnt vmcnt(5)
  s_add_u32 m0, s32, 17408
  s_add_u32 s34, s33, 4096
  buffer_load_dwordx4 v21, s[24:27], s34 offen nt lds
  v_fma_f32 v57, v57, s36, -v27
  v_fma_f32 v58, v58, s36, -v27
  v_fma_f32 v59, v59, s36, -v27
  v_exp_f32 v44, v44
  v_exp_f32 v45, v45
  v_exp_f32 v46, v46
  v_exp_f32 v47, v47
  v_exp_f32 v48, v48
  v_exp_f32 v49, v49
  v_exp_f32 v50, v50
  v_exp_f32 v51, v51
  v_exp_f32 v52, v52
  v_exp_f32 v53, v53
  v_exp_f32 v54, v54
  v_exp_f32 v55, v55
  v_exp_f32 v56, v56
  s_waitcnt vmcnt(5)
  s_add_u32 m0, s32, 18432
  s_add_u32 s34, s33, 8192
  buffer_load_dwordx4 v22, s[24:27], s34 offen nt lds
  v_exp_f32 v57, v57
  v_exp_f32 v58, v58
  v_exp_f32 v59, v59
  v_mul_f32 v26, v26, v28
  v_add_f32 v29, v44, v48
  v_add_f32 v30, v45, v49
  v_add_f32 v31, v46, v50
  v_add_f32 v32, v47, v51
  v_add_f32 v29, v29, v52
  v_add_f32 v30, v30, v53
  v_add_f32 v31, v31, v54
  v_add_f32 v32, v32, v55
  v_add_f32 v29, v29, v56
  v_add_f32 v30, v30, v57
  v_add_f32 v31, v31, v58
  s_waitcnt vmcnt(5)
  s_add_u32 m0, s32, 19456
  s_add_u32 s34, s33, 12288
  buffer_load_dwordx4 v23, s[24:27], s34 offen nt lds
  v_add_f32 v32, v32, v59
  v_add_f32 v29, v29, v30
  v_add_f32 v31, v31, v32
  v_cvt_pk_bf16_f32 v36, v44, v45
  v_cvt_pk_bf16_f32 v37, v46, v47
  v_cvt_pk_bf16_f32 v38, v48, v49
  v_cvt_pk_bf16_f32 v39, v50, v51
  v_cvt_pk_bf16_f32 v40, v52, v53
  v_cvt_pk_bf16_f32 v41, v54, v55
  v_cvt_pk_bf16_f32 v42, v56, v57
  v_cvt_pk_bf16_f32 v43, v58, v59
  v_add_f32 v26, v26, v29
  v_add_f32 v26, v26, v31
  v_mul_f32 v124, v124, v28
  v_mul_f32 v125, v125, v28
  s_waitcnt vmcnt(5)
  s_add_u32 m0, s32, 20480
  s_add_u32 s34, s33, 16384
  buffer_load_dwordx4 v20, s[24:27], s34 offen nt lds
  v_mul_f32 v126, v126, v28
  v_mul_f32 v127, v127, v28
  v_mul_f32 v128, v128, v28
  v_mul_f32 v129, v129, v28
  v_mul_f32 v130, v130, v28
  v_mul_f32 v131, v131, v28
  v_mul_f32 v132, v132, v28
  v_mul_f32 v133, v133, v28
  v_mul_f32 v134, v134, v28
  v_mul_f32 v135, v135, v28
  v_mul_f32 v136, v136, v28
  v_mul_f32 v137, v137, v28
  v_mul_f32 v138, v138, v28
  v_mul_f32 v139, v139, v28
  v_mul_f32 v140, v140, v28
  v_mul_f32 v141, v141, v28
  s_waitcnt vmcnt(5)
  s_add_u32 m0, s32, 21504
  s_add_u32 s34, s33, 20480
  buffer_load_dwordx4 v21, s[24:27], s34 offen nt lds
  v_mul_f32 v142, v142, v28
  v_mul_f32 v143, v143, v28
  v_mul_f32 v144, v144, v28
  v_mul_f32 v145, v145, v28
  v_mul_f32 v146, v146, v28
  v_mul_f32 v147, v147, v28
  v_mul_f32 v148, v148, v28
  v_mul_f32 v149, v149, v28
  v_mul_f32 v150, v150, v28
  v_mul_f32 v151, v151, v28
  v_mul_f32 v152, v152, v28
  v_mul_f32 v153, v153, v28
  v_mul_f32 v154, v154, v28
  v_mul_f32 v155, v155, v28
  v_mul_f32 v156, v156, v28
  s_waitcnt vmcnt(5)
  s_add_u32 m0, s32, 22528
  s_add_u32 s34, s33, 24576
  buffer_load_dwordx4 v22, s[24:27], s34 offen nt lds
  v_mul_f32 v157, v157, v28
  v_mul_f32 v158, v158, v28
  v_mul_f32 v159, v159, v28
  v_mul_f32 v160, v160, v28
  v_mul_f32 v161, v161, v28
  v_mul_f32 v162, v162, v28
  v_mul_f32 v163, v163, v28
  v_mul_f32 v164, v164, v28
  v_mul_f32 v165, v165, v28
  v_mul_f32 v166, v166, v28
  v_mul_f32 v167, v167, v28
  v_mul_f32 v168, v168, v28
  v_mul_f32 v169, v169, v28
  v_mul_f32 v170, v170, v28
  v_mul_f32 v171, v171, v28
  s_waitcnt vmcnt(5)
  s_add_u32 m0, s32, 23552
  s_add_u32 s34, s33, 28672
  buffer_load_dwordx4 v23, s[24:27], s34 offen nt lds
  v_mul_f32 v172, v172, v28
  v_mul_f32 v173, v173, v28
  v_mul_f32 v174, v174, v28
  v_mul_f32 v175, v175, v28
  v_mul_f32 v176, v176, v28
  v_mul_f32 v177, v177, v28
  v_mul_f32 v178, v178, v28
  v_mul_f32 v179, v179, v28
  v_mul_f32 v180, v180, v28
  v_mul_f32 v181, v181, v28
  v_mul_f32 v182, v182, v28
  v_mul_f32 v183, v183, v28
  v_mul_f32 v184, v184, v28
  v_mul_f32 v185, v185, v28
  v_mul_f32 v186, v186, v28
  v_mul_f32 v187, v187, v28
  s_waitcnt lgkmcnt(0)
  v_mfma_f32_32x32x16_bf16 v[124:139], v[92:95], v[36:39], v[124:139]
  s_waitcnt vmcnt(5)
  s_add_u32 m0, s32, 24576
  s_add_u32 s34, s33, 0
  buffer_load_dwordx4 v24, s[28:31], s34 offen nt lds
  v_mfma_f32_32x32x16_bf16 v[140:155], v[96:99], v[36:39], v[140:155]
  s_waitcnt vmcnt(5)
  s_add_u32 m0, s32, 25600
  s_add_u32 s34, s33, 4096
  buffer_load_dwordx4 v24, s[28:31], s34 offen nt lds
  v_mfma_f32_32x32x16_bf16 v[156:171], v[100:103], v[36:39], v[156:171]
  s_waitcnt vmcnt(5)
  s_add_u32 m0, s32, 26624
  s_add_u32 s34, s33, 8192
  buffer_load_dwordx4 v24, s[28:31], s34 offen nt lds
  v_mfma_f32_32x32x16_bf16 v[172:187], v[104:107], v[36:39], v[172:187]
  s_waitcnt vmcnt(5)
  s_add_u32 m0, s32, 27648
  s_add_u32 s34, s33, 12288
  buffer_load_dwordx4 v24, s[28:31], s34 offen nt lds
  v_mfma_f32_32x32x16_bf16 v[124:139], v[108:111], v[40:43], v[124:139]
  s_waitcnt vmcnt(5)
  s_add_u32 m0, s32, 28672
  s_add_u32 s34, s33, 16384
  buffer_load_dwordx4 v24, s[28:31], s34 offen nt lds
  v_mfma_f32_32x32x16_bf16 v[140:155], v[112:115], v[40:43], v[140:155]
  s_waitcnt vmcnt(5)
  s_add_u32 m0, s32, 29696
  s_add_u32 s34, s33, 20480
  buffer_load_dwordx4 v24, s[28:31], s34 offen nt lds
  v_mfma_f32_32x32x16_bf16 v[156:171], v[116:119], v[40:43], v[156:171]
  s_waitcnt vmcnt(5)
  s_add_u32 m0, s32, 30720
  s_add_u32 s34, s33, 24576
  buffer_load_dwordx4 v24, s[28:31], s34 offen nt lds
  v_mfma_f32_32x32x16_bf16 v[172:187], v[120:123], v[40:43], v[172:187]
  s_waitcnt vmcnt(5)
  s_add_u32 m0, s32, 31744
  s_add_u32 s34, s33, 28672
  buffer_load_dwordx4 v24, s[28:31], s34 offen nt lds
  s_add_u32 s33, s33, 32768
  s_sub_u32 s35, s35, 1
  s_cmp_lg_u32 s35, 0
  s_cbranch_scc1 L_loop
  ds_read_b128 v[92:95], v8 offset:0
  ds_read_b128 v[96:99], v9 offset:0
  ds_read_b128 v[100:103], v10 offset:0
  ds_read_b128 v[104:107], v11 offset:0
  ds_read_b128 v[108:111], v12 offset:0
  ds_read_b128 v[112:115], v13 offset:0
  ds_read_b128 v[116:119], v14 offset:0
  ds_read_b128 v[120:123], v15 offset:0
  s_waitcnt lgkmcnt(4)
  v_mfma_f32_32x32x16_bf16 v[44:59], v[92:95], v[60:63], 0
  v_mfma_f32_32x32x16_bf16 v[44:59], v[96:99], v[64:67], v[44:59]
  v_mfma_f32_32x32x16_bf16 v[44:59], v[100:103], v[68:71], v[44:59]
  v_mfma_f32_32x32x16_bf16 v[44:59], v[104:107], v[72:75], v[44:59]
  s_waitcnt lgkmcnt(0)
  v_mfma_f32_32x32x16_bf16 v[44:59], v[108:111], v[76:79], v[44:59]
  v_mfma_f32_32x32x16_bf16 v[44:59], v[112:115], v[80:83], v[44:59]
  v_mfma_f32_32x32x16_bf16 v[44:59], v[116:119], v[84:87], v[44:59]
  v_mfma_f32_32x32x16_bf16 v[44:59], v[120:123], v[88:91], v[44:59]
  ds_read_b64_tr_b16 v[92:93], v16 offset:0
  ds_read_b64_tr_b16 v[94:95], v16 offset:2048
  ds_read_b64_tr_b16 v[96:97], v17 offset:0
  ds_read_b64_tr_b16 v[98:99], v17 offset:2048
  ds_read_b64_tr_b16 v[100:101], v18 offset:0
  ds_read_b64_tr_b16 v[102:103], v18 offset:2048
  ds_read_b64_tr_b16 v[104:105], v19 offset:0
  ds_read_b64_tr_b16 v[106:107], v19 offset:2048
  ds_read_b64_tr_b16 v[108:109], v16 offset:4096
  ds_read_b64_tr_b16 v[110:111], v16 offset:6144
  ds_read_b64_tr_b16 v[112:113], v17 offset:4096
  ds_read_b64_tr_b16 v[114:115], v17 offset:6144
  ds_read_b64_tr_b16 v[116:117], v18 offset:4096
  ds_read_b64_tr_b16 v[118:119], v18 offset:6144
  ds_read_b64_tr_b16 v[120:121], v19 offset:4096
  ds_read_b64_tr_b16 v[122:123], v19 offset:6144
  v_max3_f32 v29, v44, v45, v46
  v_max3_f32 v30, v47, v48, v49
  v_max3_f32 v31, v50, v51, v52
  v_max3_f32 v32, v53, v54, v55
  v_max3_f32 v33, v56, v57, v58
  v_max3_f32 v29, v29, v30, v59
  v_max3_f32 v31, v31, v32, v33
  v_max_f32 v29, v29, v31
  v_mov_b32 v30, v29
  s_nop 1
  v_permlane32_swap_b32 v29, v30
  s_nop 1
  v_max3_f32 v29, v29, v30, v25
  v_mul_f32 v27, s36, v29
  v_fma_f32 v28, v25, s36, -v27
  s_waitcnt vmcnt(5)
  s_add_u32 m0, s32, 0
  s_add_u32 s34, s33, 0
  buffer_load_dwordx4 v20, s[24:27], s34 offen nt lds
  v_mov_b32 v25, v29
  v_exp_f32 v28, v28
  v_fma_f32 v44, v44, s36, -v27
  v_fma_f32 v45, v45, s36, -v27
  v_fma_f32 v46, v46, s36, -v27
  v_fma_f32 v47, v47, s36, -v27
  v_fma_f32 v48, v48, s36, -v27
  v_fma_f32 v49, v49, s36, -v27
  v_fma_f32 v50, v50, s36, -v27
  v_fma_f32 v51, v51, s36, -v27
  v_fma_f32 v52, v52, s36, -v27
  v_fma_f32 v53, v53, s36, -v27
  v_fma_f32 v54, v54, s36, -v27
  v_fma_f32 v55, v55, s36, -v27
  v_fma_f32 v56, v56, s36, -v27
  s_waitcnt vmcnt(5)
  s_add_u32 m0, s32, 1024
  s_add_u32 s34, s33, 4096
  buffer_load_dwordx4 v21, s[24:27], s34 offen nt lds
  v_fma_f32 v57, v57, s36, -v27
  v_fma_f32 v58, v58, s36, -v27
  v_fma_f32 v59, v59, s36, -v27
  v_exp_f32 v44, v44
  v_exp_f32 v45, v45
  v_exp_f32 v46, v46
  v_exp_f32 v47, v47
  v_exp_f32 v48, v48
  v_exp_f32 v49, v49
  v_exp_f32 v50, v50
  v_exp_f32 v51, v51
  v_exp_f32 v52, v52
  v_exp_f32 v53, v53
  v_exp_f32 v54, v54
  v_exp_f32 v55, v55
  v_exp_f32 v56, v56
  s_waitcnt vmcnt(5)
  s_add_u32 m0, s32, 2048
  s_add_u32 s34, s33, 8192
  buffer_load_dwordx4 v22, s[24:27], s34 offen nt lds
  v_exp_f32 v57, v57
  v_exp_f32 v58, v58
  v_exp_f32 v59, v59
  v_mul_f32 v26, v26, v28
  v_add_f32 v29, v44, v48
  v_add_f32 v30, v45, v49
  v_add_f32 v31, v46, v50
  v_add_f32 v32, v47, v51
  v_add_f32 v29, v29, v52
  v_add_f32 v30, v30, v53
  v_add_f32 v31, v31, v54
  v_add_f32 v32, v32, v55
  v_add_f32 v29, v29, v56
  v_add_f32 v30, v30, v57
  v_add_f32 v31, v31, v58
  s_waitcnt vmcnt(5)
  s_add_u32 m0, s32, 3072
  s_add_u32 s34, s33, 12288
  buffer_load_dwordx4 v23, s[24:27], s34 offen nt lds
  v_add_f32 v32, v32, v59
  v_add_f32 v29, v29, v30
  v_add_f32 v31, v31, v32
  v_cvt_pk_bf16_f32 v36, v44, v45
  v_cvt_pk_bf16_f32 v37, v46, v47
  v_cvt_pk_bf16_f32 v38, v48, v49
  v_cvt_pk_bf16_f32 v39, v50, v51
  v_cvt_pk_bf16_f32 v40, v52, v53
  v_cvt_pk_bf16_f32 v41, v54, v55
  v_cvt_pk_bf16_f32 v42, v56, v57
  v_cvt_pk_bf16_f32 v43, v58, v59
  v_add_f32 v26, v26, v29
  v_add_f32 v26, v26, v31
  v_mul_f32 v124, v124, v28
  v_mul_f32 v125, v125, v28
  s_waitcnt vmcnt(5)
  s_add_u32 m0, s32, 4096
  s_add_u32 s34, s33, 16384
  buffer_load_dwordx4 v20, s[24:27], s34 offen nt lds
  v_mul_f32 v126, v126, v28
  v_mul_f32 v127, v127, v28
  v_mul_f32 v128, v128, v28
  v_mul_f32 v129, v129, v28
  v_mul_f32 v130, v130, v28
  v_mul_f32 v131, v131, v28
  v_mul_f32 v132, v132, v28
  v_mul_f32 v133, v133, v28
  v_mul_f32 v134, v134, v28
  v_mul_f32 v135, v135, v28
  v_mul_f32 v136, v136, v28
  v_mul_f32 v137, v137, v28
  v_mul_f32 v138, v138, v28
  v_mul_f32 v139, v139, v28
  v_mul_f32 v140, v140, v28
  v_mul_f32 v141, v141, v28
  s_waitcnt vmcnt(5)
  s_add_u32 m0, s32, 5120
  s_add_u32 s34, s33, 20480
  buffer_load_dwordx4 v21, s[24:27], s34 offen nt lds
  v_mul_f32 v142, v142, v28
  v_mul_f32 v143, v143, v28
  v_mul_f32 v144, v144, v28
  v_mul_f32 v145, v145, v28
  v_mul_f32 v146, v146, v28
  v_mul_f32 v147, v147, v28
  v_mul_f32 v148, v148, v28
  v_mul_f32 v149, v149, v28
  v_mul_f32 v150, v150, v28
  v_mul_f32 v151, v151, v28
  v_mul_f32 v152, v152, v28
  v_mul_f32 v153, v153, v28
  v_mul_f32 v154, v154, v28
  v_mul_f32 v155, v155, v28
  v_mul_f32 v156, v156, v28
  s_waitcnt vmcnt(5)
  s_add_u32 m0, s32, 6144
  s_add_u32 s34, s33, 24576
  buffer_load_dwordx4 v22, s[24:27], s34 offen nt lds
  v_mul_f32 v157, v157, v28
  v_mul_f32 v158, v158, v28
  v_mul_f32 v159, v159, v28
  v_mul_f32 v160, v160, v28
  v_mul_f32 v161, v161, v28
  v_mul_f32 v162, v162, v28
  v_mul_f32 v163, v163, v28
  v_mul_f32 v164, v164, v28
  v_mul_f32 v165, v165, v28
  v_mul_f32 v166, v166, v28
  v_mul_f32 v167, v167, v28
  v_mul_f32 v168, v168, v28
  v_mul_f32 v169, v169, v28
  v_mul_f32 v170, v170, v28
  v_mul_f32 v171, v171, v28
  s_waitcnt vmcnt(5)
  s_add_u32 m0, s32, 7168
  s_add_u32 s34, s33, 28672
  buffer_load_dwordx4 v23, s[24:27], s34 offen nt lds
  v_mul_f32 v172, v172, v28
  v_mul_f32 v173, v173, v28
  v_mul_f32 v174, v174, v28
  v_mul_f32 v175, v175, v28
  v_mul_f32 v176, v176, v28
  v_mul_f32 v177, v177, v28
  v_mul_f32 v178, v178, v28
  v_mul_f32 v179, v179, v28
  v_mul_f32 v180, v180, v28
  v_mul_f32 v181, v181, v28
  v_mul_f32 v182, v182, v28
  v_mul_f32 v183, v183, v28
  v_mul_f32 v184, v184, v28
  v_mul_f32 v185, v185, v28
  v_mul_f32 v186, v186, v28
  v_mul_f32 v187, v187, v28
  v_perm_b32 v1, v196, v188, s40
  v_perm_b32 v196, v196, v188, s41
  v_mov_b32 v188, v1
  v_perm_b32 v1, v213, v205, s40
  v_perm_b32 v213, v213, v205, s41
  v_mov_b32 v205, v1
  v_perm_b32 v1, v230, v222, s40
  v_perm_b32 v230, v230, v222, s41
  v_mov_b32 v222, v1
  v_perm_b32 v1, v247, v239, s40
  v_perm_b32 v247, v247, v239, s41
  v_mov_b32 v239, v1
  v_perm_b32 v1, v197, v189, s40
  v_perm_b32 v2, v197, v189, s41
  v_perm_b32 v189, v212, v204, s40
  v_perm_b32 v197, v212, v204, s41
  v_mov_b32 v204, v1
  v_mov_b32 v212, v2
  v_perm_b32 v1, v198, v190, s40
  v_perm_b32 v2, v198, v190, s41
  v_perm_b32 v190, v228, v220, s40
  v_perm_b32 v198, v228, v220, s41
  v_mov_b32 v220, v1
  v_mov_b32 v228, v2
  v_perm_b32 v1, v199, v191, s40
  v_perm_b32 v2, v199, v191, s41
  v_perm_b32 v191, v244, v236, s40
  v_perm_b32 v199, v244, v236, s41
  v_mov_b32 v236, v1
  v_mov_b32 v244, v2
  v_perm_b32 v1, v214, v206, s40
  v_perm_b32 v2, v214, v206, s41
  v_perm_b32 v206, v229, v221, s40
  v_perm_b32 v214, v229, v221, s41
  v_mov_b32 v221, v1
  v_mov_b32 v229, v2
  v_perm_b32 v1, v215, v207, s40
  v_perm_b32 v2, v215, v207, s41
  v_perm_b32 v207, v245, v237, s40
  v_perm_b32 v215, v245, v237, s41
  v_mov_b32 v237, v1
  v_mov_b32 v245, v2
  v_perm_b32 v1, v231, v223, s40
  v_perm_b32 v2, v231, v223, s41
  v_perm_b32 v223, v246, v238, s40
  v_perm_b32 v231, v246, v238, s41
  v_mov_b32 v238, v1
  v_mov_b32 v246, v2
  v_perm_b32 v1, v200, v192, s40
  v_perm_b32 v200, v200, v192, s41
  v_mov_b32 v192, v1
  v_perm_b32 v1, v217, v209, s40
  v_perm_b32 v217, v217, v209, s41
  v_mov_b32 v209, v1
  v_perm_b32 v1, v234, v226, s40
  v_perm_b32 v234, v234, v226, s41
  v_mov_b32 v226, v1
  v_perm_b32 v1, v251, v243, s40
  v_perm_b32 v251, v251, v243, s41
  v_mov_b32 v243, v1
  v_perm_b32 v1, v201, v193, s40
  v_perm_b32 v2, v201, v193, s41
  v_perm_b32 v193, v216, v208, s40
  v_perm_b32 v201, v216, v208, s41
  v_mov_b32 v208, v1
  v_mov_b32 v216, v2
  v_perm_b32 v1, v202, v194, s40
  v_perm_b32 v2, v202, v194, s41
  v_perm_b32 v194, v232, v224, s40
  v_perm_b32 v202, v232, v224, s41
  v_mov_b32 v224, v1
  v_mov_b32 v232, v2
  v_perm_b32 v1, v203, v195, s40
  v_perm_b32 v2, v203, v195, s41
  v_perm_b32 v195, v248, v240, s40
  v_perm_b32 v203, v248, v240, s41
  v_mov_b32 v240, v1
  v_mov_b32 v248, v2
  v_perm_b32 v1, v218, v210, s40
  v_perm_b32 v2, v218, v210, s41
  v_perm_b32 v210, v233, v225, s40
  v_perm_b32 v218, v233, v225, s41
  v_mov_b32 v225, v1
  v_mov_b32 v233, v2
  v_perm_b32 v1, v219, v211, s40
  v_perm_b32 v2, v219, v211, s41
  v_perm_b32 v211, v249, v241, s40
  v_perm_b32 v219, v249, v241, s41
  v_mov_b32 v241, v1
  v_mov_b32 v249, v2
  v_perm_b32 v1, v235, v227, s40
  v_perm_b32 v2, v235, v227, s41
  v_perm_b32 v227, v250, v242, s40
  v_perm_b32 v235, v250, v242, s41
  v_mov_b32 v242, v1
  v_mov_b32 v250, v2
  s_waitcnt lgkmcnt(0)
  v_mfma_f32_32x32x16_bf16 v[124:139], v[92:95], v[36:39], v[124:139]
  s_waitcnt vmcnt(5)
  s_add_u32 m0, s32, 8192
  s_add_u32 s34, s33, 0
  buffer_load_dwordx4 v24, s[28:31], s34 offen nt lds
  v_mfma_f32_32x32x16_bf16 v[140:155], v[96:99], v[36:39], v[140:155]
  s_waitcnt vmcnt(5)
  s_add_u32 m0, s32, 9216
  s_add_u32 s34, s33, 4096
  buffer_load_dwordx4 v24, s[28:31], s34 offen nt lds
  v_mfma_f32_32x32x16_bf16 v[156:171], v[100:103], v[36:39], v[156:171]
  s_waitcnt vmcnt(5)
  s_add_u32 m0, s32, 10240
  s_add_u32 s34, s33, 8192
  buffer_load_dwordx4 v24, s[28:31], s34 offen nt lds
  v_mfma_f32_32x32x16_bf16 v[172:187], v[104:107], v[36:39], v[172:187]
  s_waitcnt vmcnt(5)
  s_add_u32 m0, s32, 11264
  s_add_u32 s34, s33, 12288
  buffer_load_dwordx4 v24, s[28:31], s34 offen nt lds
  v_mfma_f32_32x32x16_bf16 v[124:139], v[108:111], v[40:43], v[124:139]
  s_waitcnt vmcnt(5)
  s_add_u32 m0, s32, 12288
  s_add_u32 s34, s33, 16384
  buffer_load_dwordx4 v24, s[28:31], s34 offen nt lds
  v_mfma_f32_32x32x16_bf16 v[140:155], v[112:115], v[40:43], v[140:155]
  s_waitcnt vmcnt(5)
  s_add_u32 m0, s32, 13312
  s_add_u32 s34, s33, 20480
  buffer_load_dwordx4 v24, s[28:31], s34 offen nt lds
  v_mfma_f32_32x32x16_bf16 v[156:171], v[116:119], v[40:43], v[156:171]
  s_waitcnt vmcnt(5)
  s_add_u32 m0, s32, 14336
  s_add_u32 s34, s33, 24576
  buffer_load_dwordx4 v24, s[28:31], s34 offen nt lds
  v_mfma_f32_32x32x16_bf16 v[172:187], v[120:123], v[40:43], v[172:187]
  s_waitcnt vmcnt(5)
  s_add_u32 m0, s32, 15360
  s_add_u32 s34, s33, 28672
  buffer_load_dwordx4 v24, s[28:31], s34 offen nt lds
  s_add_u32 s33, s33, 32768
  ds_read_b128 v[92:95], v8 offset:16384
  ds_read_b128 v[96:99], v9 offset:16384
  ds_read_b128 v[100:103], v10 offset:16384
  ds_read_b128 v[104:107], v11 offset:16384
  ds_read_b128 v[108:111], v12 offset:16384
  ds_read_b128 v[112:115], v13 offset:16384
  ds_read_b128 v[116:119], v14 offset:16384
  ds_read_b128 v[120:123], v15 offset:16384
  s_waitcnt lgkmcnt(4)
  v_mfma_f32_32x32x16_bf16 v[44:59], v[92:95], v[60:63], 0
  v_mfma_f32_32x32x16_bf16 v[44:59], v[96:99], v[64:67], v[44:59]
  v_mfma_f32_32x32x16_bf16 v[44:59], v[100:103], v[68:71], v[44:59]
  v_mfma_f32_32x32x16_bf16 v[44:59], v[104:107], v[72:75], v[44:59]
  s_waitcnt lgkmcnt(0)
  v_mfma_f32_32x32x16_bf16 v[44:59], v[108:111], v[76:79], v[44:59]
  v_mfma_f32_32x32x16_bf16 v[44:59], v[112:115], v[80:83], v[44:59]
  v_mfma_f32_32x32x16_bf16 v[44:59], v[116:119], v[84:87], v[44:59]
  v_mfma_f32_32x32x16_bf16 v[44:59], v[120:123], v[88:91], v[44:59]
  ds_read_b64_tr_b16 v[92:93], v16 offset:16384
  ds_read_b64_tr_b16 v[94:95], v16 offset:18432
  ds_read_b64_tr_b16 v[96:97], v17 offset:16384
  ds_read_b64_tr_b16 v[98:99], v17 offset:18432
  ds_read_b64_tr_b16 v[100:101], v18 offset:16384
  ds_read_b64_tr_b16 v[102:103], v18 offset:18432
  ds_read_b64_tr_b16 v[104:105], v19 offset:16384
  ds_read_b64_tr_b16 v[106:107], v19 offset:18432
  ds_read_b64_tr_b16 v[108:109], v16 offset:20480
  ds_read_b64_tr_b16 v[110:111], v16 offset:22528
  ds_read_b64_tr_b16 v[112:113], v17 offset:20480
  ds_read_b64_tr_b16 v[114:115], v17 offset:22528
  ds_read_b64_tr_b16 v[116:117], v18 offset:20480
  ds_read_b64_tr_b16 v[118:119], v18 offset:22528
  ds_read_b64_tr_b16 v[120:121], v19 offset:20480
  ds_read_b64_tr_b16 v[122:123], v19 offset:22528
  v_max3_f32 v29, v44, v45, v46
  v_max3_f32 v30, v47, v48, v49
  v_max3_f32 v31, v50, v51, v52
  v_max3_f32 v32, v53, v54, v55
  v_max3_f32 v33, v56, v57, v58
  v_max3_f32 v29, v29, v30, v59
  v_max3_f32 v31, v31, v32, v33
  v_max_f32 v29, v29, v31
  v_mov_b32 v30, v29
  s_nop 1
  v_permlane32_swap_b32 v29, v30
  s_nop 1
  v_max3_f32 v29, v29, v30, v25
  v_mul_f32 v27, s36, v29
  v_fma_f32 v28, v25, s36, -v27
  s_waitcnt vmcnt(5)
  s_add_u32 m0, s32, 16384
  s_add_u32 s34, s33, 0
  buffer_load_dwordx4 v20, s[24:27], s34 offen nt lds
  v_mov_b32 v25, v29
  v_exp_f32 v28, v28
  v_fma_f32 v44, v44, s36, -v27
  v_fma_f32 v45, v45, s36, -v27
  v_fma_f32 v46, v46, s36, -v27
  v_fma_f32 v47, v47, s36, -v27
  v_fma_f32 v48, v48, s36, -v27
  v_fma_f32 v49, v49, s36, -v27
  v_fma_f32 v50, v50, s36, -v27
  v_fma_f32 v51, v51, s36, -v27
  v_fma_f32 v52, v52, s36, -v27
  v_fma_f32 v53, v53, s36, -v27
  v_fma_f32 v54, v54, s36, -v27
  v_fma_f32 v55, v55, s36, -v27
  v_fma_f32 v56, v56, s36, -v27
  s_waitcnt vmcnt(5)
  s_add_u32 m0, s32, 17408
  s_add_u32 s34, s33, 4096
  buffer_load_dwordx4 v21, s[24:27], s34 offen nt lds
  v_fma_f32 v57, v57, s36, -v27
  v_fma_f32 v58, v58, s36, -v27
  v_fma_f32 v59, v59, s36, -v27
  v_exp_f32 v44, v44
  v_exp_f32 v45, v45
  v_exp_f32 v46, v46
  v_exp_f32 v47, v47
  v_exp_f32 v48, v48
  v_exp_f32 v49, v49
  v_exp_f32 v50, v50
  v_exp_f32 v51, v51
  v_exp_f32 v52, v52
  v_exp_f32 v53, v53
  v_exp_f32 v54, v54
  v_exp_f32 v55, v55
  v_exp_f32 v56, v56
  s_waitcnt vmcnt(5)
  s_add_u32 m0, s32, 18432
  s_add_u32 s34, s33, 8192
  buffer_load_dwordx4 v22, s[24:27], s34 offen nt lds
  v_exp_f32 v57, v57
  v_exp_f32 v58, v58
  v_exp_f32 v59, v59
  v_mul_f32 v26, v26, v28
  v_add_f32 v29, v44, v48
  v_add_f32 v30, v45, v49
  v_add_f32 v31, v46, v50
  v_add_f32 v32, v47, v51
  v_add_f32 v29, v29, v52
  v_add_f32 v30, v30, v53
  v_add_f32 v31, v31, v54
  v_add_f32 v32, v32, v55
  v_add_f32 v29, v29, v56
  v_add_f32 v30, v30, v57
  v_add_f32 v31, v31, v58
  s_waitcnt vmcnt(5)
  s_add_u32 m0, s32, 19456
  s_add_u32 s34, s33, 12288
  buffer_load_dwordx4 v23, s[24:27], s34 offen nt lds
  v_add_f32 v32, v32, v59
  v_add_f32 v29, v29, v30
  v_add_f32 v31, v31, v32
  v_cvt_pk_bf16_f32 v36, v44, v45
  v_cvt_pk_bf16_f32 v37, v46, v47
  v_cvt_pk_bf16_f32 v38, v48, v49
  v_cvt_pk_bf16_f32 v39, v50, v51
  v_cvt_pk_bf16_f32 v40, v52, v53
  v_cvt_pk_bf16_f32 v41, v54, v55
  v_cvt_pk_bf16_f32 v42, v56, v57
  v_cvt_pk_bf16_f32 v43, v58, v59
  v_add_f32 v26, v26, v29
  v_add_f32 v26, v26, v31
  v_mul_f32 v124, v124, v28
  v_mul_f32 v125, v125, v28
  s_waitcnt vmcnt(5)
  s_add_u32 m0, s32, 20480
  s_add_u32 s34, s33, 16384
  buffer_load_dwordx4 v20, s[24:27], s34 offen nt lds
  v_mul_f32 v126, v126, v28
  v_mul_f32 v127, v127, v28
  v_mul_f32 v128, v128, v28
  v_mul_f32 v129, v129, v28
  v_mul_f32 v130, v130, v28
  v_mul_f32 v131, v131, v28
  v_mul_f32 v132, v132, v28
  v_mul_f32 v133, v133, v28
  v_mul_f32 v134, v134, v28
  v_mul_f32 v135, v135, v28
  v_mul_f32 v136, v136, v28
  v_mul_f32 v137, v137, v28
  v_mul_f32 v138, v138, v28
  v_mul_f32 v139, v139, v28
  v_mul_f32 v140, v140, v28
  v_mul_f32 v141, v141, v28
  s_waitcnt vmcnt(5)
  s_add_u32 m0, s32, 21504
  s_add_u32 s34, s33, 20480
  buffer_load_dwordx4 v21, s[24:27], s34 offen nt lds
  v_mul_f32 v142, v142, v28
  v_mul_f32 v143, v143, v28
  v_mul_f32 v144, v144, v28
  v_mul_f32 v145, v145, v28
  v_mul_f32 v146, v146, v28
  v_mul_f32 v147, v147, v28
  v_mul_f32 v148, v148, v28
  v_mul_f32 v149, v149, v28
  v_mul_f32 v150, v150, v28
  v_mul_f32 v151, v151, v28
  v_mul_f32 v152, v152, v28
  v_mul_f32 v153, v153, v28
  v_mul_f32 v154, v154, v28
  v_mul_f32 v155, v155, v28
  v_mul_f32 v156, v156, v28
  s_waitcnt vmcnt(5)
  s_add_u32 m0, s32, 22528
  s_add_u32 s34, s33, 24576
  buffer_load_dwordx4 v22, s[24:27], s34 offen nt lds
  v_mul_f32 v157, v157, v28
  v_mul_f32 v158, v158, v28
  v_mul_f32 v159, v159, v28
  v_mul_f32 v160, v160, v28
  v_mul_f32 v161, v161, v28
  v_mul_f32 v162, v162, v28
  v_mul_f32 v163, v163, v28
  v_mul_f32 v164, v164, v28
  v_mul_f32 v165, v165, v28
  v_mul_f32 v166, v166, v28
  v_mul_f32 v167, v167, v28
  v_mul_f32 v168, v168, v28
  v_mul_f32 v169, v169, v28
  v_mul_f32 v170, v170, v28
  v_mul_f32 v171, v171, v28
  s_waitcnt vmcnt(5)
  s_add_u32 m0, s32, 23552
  s_add_u32 s34, s33, 28672
  buffer_load_dwordx4 v23, s[24:27], s34 offen nt lds
  v_mul_f32 v172, v172, v28
  v_mul_f32 v173, v173, v28
  v_mul_f32 v174, v174, v28
  v_mul_f32 v175, v175, v28
  v_mul_f32 v176, v176, v28
  v_mul_f32 v177, v177, v28
  v_mul_f32 v178, v178, v28
  v_mul_f32 v179, v179, v28
  v_mul_f32 v180, v180, v28
  v_mul_f32 v181, v181, v28
  v_mul_f32 v182, v182, v28
  v_mul_f32 v183, v183, v28
  v_mul_f32 v184, v184, v28
  v_mul_f32 v185, v185, v28
  v_mul_f32 v186, v186, v28
  v_mul_f32 v187, v187, v28
  s_waitcnt lgkmcnt(0)
  v_mfma_f32_32x32x16_bf16 v[124:139], v[92:95], v[36:39], v[124:139]
  s_waitcnt vmcnt(5)
  s_add_u32 m0, s32, 24576
  s_add_u32 s34, s33, 0
  buffer_load_dwordx4 v24, s[28:31], s34 offen nt lds
  v_mfma_f32_32x32x16_bf16 v[140:155], v[96:99], v[36:39], v[140:155]
  s_waitcnt vmcnt(5)
  s_add_u32 m0, s32, 25600
  s_add_u32 s34, s33, 4096
  buffer_load_dwordx4 v24, s[28:31], s34 offen nt lds
  v_mfma_f32_32x32x16_bf16 v[156:171], v[100:103], v[36:39], v[156:171]
  s_waitcnt vmcnt(5)
  s_add_u32 m0, s32, 26624
  s_add_u32 s34, s33, 8192
  buffer_load_dwordx4 v24, s[28:31], s34 offen nt lds
  v_mfma_f32_32x32x16_bf16 v[172:187], v[104:107], v[36:39], v[172:187]
  v_mfma_f32_32x32x16_bf16 v[124:139], v[108:111], v[40:43], v[124:139]
  v_mfma_f32_32x32x16_bf16 v[140:155], v[112:115], v[40:43], v[140:155]
  v_mfma_f32_32x32x16_bf16 v[156:171], v[116:119], v[40:43], v[156:171]
  v_mfma_f32_32x32x16_bf16 v[172:187], v[120:123], v[40:43], v[172:187]
  s_add_u32 s33, s33, 32768
  ds_read_b128 v[92:95], v8 offset:0
  ds_read_b128 v[96:99], v9 offset:0
  ds_read_b128 v[100:103], v10 offset:0
  ds_read_b128 v[104:107], v11 offset:0
  ds_read_b128 v[108:111], v12 offset:0
  ds_read_b128 v[112:115], v13 offset:0
  ds_read_b128 v[116:119], v14 offset:0
  ds_read_b128 v[120:123], v15 offset:0
  s_waitcnt lgkmcnt(4)
  v_mfma_f32_32x32x16_bf16 v[44:59], v[92:95], v[60:63], 0
  v_mfma_f32_32x32x16_bf16 v[44:59], v[96:99], v[64:67], v[44:59]
  v_mfma_f32_32x32x16_bf16 v[44:59], v[100:103], v[68:71], v[44:59]
  v_mfma_f32_32x32x16_bf16 v[44:59], v[104:107], v[72:75], v[44:59]
  s_waitcnt lgkmcnt(0)
  v_mfma_f32_32x32x16_bf16 v[44:59], v[108:111], v[76:79], v[44:59]
  v_mfma_f32_32x32x16_bf16 v[44:59], v[112:115], v[80:83], v[44:59]
  v_mfma_f32_32x32x16_bf16 v[44:59], v[116:119], v[84:87], v[44:59]
  v_mfma_f32_32x32x16_bf16 v[44:59], v[120:123], v[88:91], v[44:59]
  ds_read_b64_tr_b16 v[92:93], v16 offset:0
  ds_read_b64_tr_b16 v[94:95], v16 offset:2048
  ds_read_b64_tr_b16 v[96:97], v17 offset:0
  ds_read_b64_tr_b16 v[98:99], v17 offset:2048
  ds_read_b64_tr_b16 v[100:101], v18 offset:0
  ds_read_b64_tr_b16 v[102:103], v18 offset:2048
  ds_read_b64_tr_b16 v[104:105], v19 offset:0
  ds_read_b64_tr_b16 v[106:107], v19 offset:2048
  ds_read_b64_tr_b16 v[108:109], v16 offset:4096
  ds_read_b64_tr_b16 v[110:111], v16 offset:6144
  ds_read_b64_tr_b16 v[112:113], v17 offset:4096
  ds_read_b64_tr_b16 v[114:115], v17 offset:6144
  ds_read_b64_tr_b16 v[116:117], v18 offset:4096
  ds_read_b64_tr_b16 v[118:119], v18 offset:6144
  ds_read_b64_tr_b16 v[120:121], v19 offset:4096
  ds_read_b64_tr_b16 v[122:123], v19 offset:6144
  v_max3_f32 v29, v44, v45, v46
  v_max3_f32 v30, v47, v48, v49
  v_max3_f32 v31, v50, v51, v52
  v_max3_f32 v32, v53, v54, v55
  v_max3_f32 v33, v56, v57, v58
  v_max3_f32 v29, v29, v30, v59
  v_max3_f32 v31, v31, v32, v33
  v_max_f32 v29, v29, v31
  v_mov_b32 v30, v29
  s_waitcnt vmcnt(5)
  s_add_u32 m0, s32, 27648
  s_add_u32 s34, s33, -20480
  buffer_load_dwordx4 v24, s[28:31], s34 offen nt lds
  s_nop 1
  v_permlane32_swap_b32 v29, v30
  s_nop 1
  v_max3_f32 v29, v29, v30, v25
  v_mul_f32 v27, s36, v29
  v_fma_f32 v28, v25, s36, -v27
  v_mov_b32 v25, v29
  v_exp_f32 v28, v28
  v_fma_f32 v44, v44, s36, -v27
  v_fma_f32 v45, v45, s36, -v27
  s_add_u32 m0, s32, 0
  s_mov_b32 s34, 262144
  buffer_load_dwordx4 v252, s[44:47], s34 offen  lds
  v_fma_f32 v46, v46, s36, -v27
  v_fma_f32 v47, v47, s36, -v27
  v_fma_f32 v48, v48, s36, -v27
  v_fma_f32 v49, v49, s36, -v27
  v_fma_f32 v50, v50, s36, -v27
  v_fma_f32 v51, v51, s36, -v27
  v_fma_f32 v52, v52, s36, -v27
  v_fma_f32 v53, v53, s36, -v27
  v_fma_f32 v54, v54, s36, -v27
  v_fma_f32 v55, v55, s36, -v27
  s_waitcnt vmcnt(6)
  s_add_u32 m0, s32, 28672
  s_add_u32 s34, s33, -16384
  buffer_load_dwordx4 v24, s[28:31], s34 offen nt lds
  v_fma_f32 v56, v56, s36, -v27
  v_fma_f32 v57, v57, s36, -v27
  v_fma_f32 v58, v58, s36, -v27
  v_fma_f32 v59, v59, s36, -v27
  v_exp_f32 v44, v44
  v_exp_f32 v45, v45
  v_exp_f32 v46, v46
  v_exp_f32 v47, v47
  v_exp_f32 v48, v48
  v_exp_f32 v49, v49
  s_add_u32 m0, s32, 1024
  s_mov_b32 s34, 263168
  buffer_load_dwordx4 v252, s[44:47], s34 offen  lds
  v_exp_f32 v50, v50
  v_exp_f32 v51, v51
  v_exp_f32 v52, v52
  v_exp_f32 v53, v53
  v_exp_f32 v54, v54
  v_exp_f32 v55, v55
  v_exp_f32 v56, v56
  v_exp_f32 v57, v57
  v_exp_f32 v58, v58
  v_exp_f32 v59, v59
  s_waitcnt vmcnt(7)
  s_add_u32 m0, s32, 29696
  s_add_u32 s34, s33, -12288
  buffer_load_dwordx4 v24, s[28:31], s34 offen nt lds
  v_mul_f32 v26, v26, v28
  v_add_f32 v29, v44, v48
  v_add_f32 v30, v45, v49
  v_add_f32 v31, v46, v50
  v_add_f32 v32, v47, v51
  v_add_f32 v29, v29, v52
  v_add_f32 v30, v30, v53
  v_add_f32 v31, v31, v54
  v_add_f32 v32, v32, v55
  v_add_f32 v29, v29, v56
  s_add_u32 m0, s32, 2048
  s_mov_b32 s34, 264192
  buffer_load_dwordx4 v252, s[44:47], s34 offen  lds
  v_add_f32 v30, v30, v57
  v_add_f32 v31, v31, v58
  v_add_f32 v32, v32, v59
  v_add_f32 v29, v29, v30
  v_add_f32 v31, v31, v32
  v_cvt_pk_bf16_f32 v36, v44, v45
  v_cvt_pk_bf16_f32 v37, v46, v47
  v_cvt_pk_bf16_f32 v38, v48, v49
  v_cvt_pk_bf16_f32 v39, v50, v51
  v_cvt_pk_bf16_f32 v40, v52, v53
  s_waitcnt vmcnt(8)
  s_add_u32 m0, s32, 30720
  s_add_u32 s34, s33, -8192
  buffer_load_dwordx4 v24, s[28:31], s34 offen nt lds
  v_cvt_pk_bf16_f32 v41, v54, v55
  v_cvt_pk_bf16_f32 v42, v56, v57
  v_cvt_pk_bf16_f32 v43, v58, v59
  v_add_f32 v26, v26, v29
  v_add_f32 v26, v26, v31
  v_mul_f32 v124, v124, v28
  v_mul_f32 v125, v125, v28
  v_mul_f32 v126, v126, v28
  v_mul_f32 v127, v127, v28
  s_add_u32 m0, s32, 3072
  s_mov_b32 s34, 265216
  buffer_load_dwordx4 v252, s[44:47], s34 offen  lds
  v_mul_f32 v128, v128, v28
  v_mul_f32 v129, v129, v28
  v_mul_f32 v130, v130, v28
  v_mul_f32 v131, v131, v28
  v_mul_f32 v132, v132, v28
  v_mul_f32 v133, v133, v28
  v_mul_f32 v134, v134, v28
  v_mul_f32 v135, v135, v28
  v_mul_f32 v136, v136, v28
  v_mul_f32 v137, v137, v28
  s_waitcnt vmcnt(9)
  s_add_u32 m0, s32, 31744
  s_add_u32 s34, s33, -4096
  buffer_load_dwordx4 v24, s[28:31], s34 offen nt lds
  v_mul_f32 v138, v138, v28
  v_mul_f32 v139, v139, v28
  v_mul_f32 v140, v140, v28
  v_mul_f32 v141, v141, v28
  v_mul_f32 v142, v142, v28
  v_mul_f32 v143, v143, v28
  v_mul_f32 v144, v144, v28
  v_mul_f32 v145, v145, v28
  v_mul_f32 v146, v146, v28
  v_mul_f32 v147, v147, v28
  s_add_u32 m0, s32, 4096
  s_mov_b32 s34, 266240
  buffer_load_dwordx4 v252, s[44:47], s34 offen  lds
  v_mul_f32 v148, v148, v28
  v_mul_f32 v149, v149, v28
  v_mul_f32 v150, v150, v28
  v_mul_f32 v151, v151, v28
  v_mul_f32 v152, v152, v28
  v_mul_f32 v153, v153, v28
  v_mul_f32 v154, v154, v28
  v_mul_f32 v155, v155, v28
  v_mul_f32 v156, v156, v28
  v_mul_f32 v157, v157, v28
  s_add_u32 m0, s32, 5120
  s_mov_b32 s34, 267264
  buffer_load_dwordx4 v252, s[44:47], s34 offen  lds
  v_mul_f32 v158, v158, v28
  v_mul_f32 v159, v159, v28
  v_mul_f32 v160, v160, v28
  v_mul_f32 v161, v161, v28
  v_mul_f32 v162, v162, v28
  v_mul_f32 v163, v163, v28
  v_mul_f32 v164, v164, v28
  v_mul_f32 v165, v165, v28
  v_mul_f32 v166, v166, v28
  v_mul_f32 v167, v167, v28
  s_add_u32 m0, s32, 6144
  s_mov_b32 s34, 268288
  buffer_load_dwordx4 v252, s[44:47], s34 offen  lds
  v_mul_f32 v168, v168, v28
  v_mul_f32 v169, v169, v28
  v_mul_f32 v170, v170, v28
  v_mul_f32 v171, v171, v28
  v_mul_f32 v172, v172, v28
  v_mul_f32 v173, v173, v28
  v_mul_f32 v174, v174, v28
  v_mul_f32 v175, v175, v28
  v_mul_f32 v176, v176, v28
  v_mul_f32 v177, v177, v28
  s_add_u32 m0, s32, 7168
  s_mov_b32 s34, 269312
  buffer_load_dwordx4 v252, s[44:47], s34 offen  lds
  v_mul_f32 v178, v178, v28
  v_mul_f32 v179, v179, v28
  v_mul_f32 v180, v180, v28
  v_mul_f32 v181, v181, v28
  v_mul_f32 v182, v182, v28
  v_mul_f32 v183, v183, v28
  v_mul_f32 v184, v184, v28
  v_mul_f32 v185, v185, v28
  v_mul_f32 v186, v186, v28
  v_mul_f32 v187, v187, v28
  s_waitcnt lgkmcnt(0)
  v_mfma_f32_32x32x16_bf16 v[124:139], v[92:95], v[36:39], v[124:139]
  s_add_u32 m0, s32, 8192
  s_mov_b32 s34, 294912
  buffer_load_dwordx4 v252, s[44:47], s34 offen  lds
  v_mfma_f32_32x32x16_bf16 v[140:155], v[96:99], v[36:39], v[140:155]
  s_add_u32 m0, s32, 9216
  s_mov_b32 s34, 295936
  buffer_load_dwordx4 v252, s[44:47], s34 offen  lds
  v_mfma_f32_32x32x16_bf16 v[156:171], v[100:103], v[36:39], v[156:171]
  s_add_u32 m0, s32, 10240
  s_mov_b32 s34, 296960
  buffer_load_dwordx4 v252, s[44:47], s34 offen  lds
  v_mfma_f32_32x32x16_bf16 v[172:187], v[104:107], v[36:39], v[172:187]
  s_add_u32 m0, s32, 11264
  s_mov_b32 s34, 297984
  buffer_load_dwordx4 v252, s[44:47], s34 offen  lds
  v_mfma_f32_32x32x16_bf16 v[124:139], v[108:111], v[40:43], v[124:139]
  s_add_u32 m0, s32, 12288
  s_mov_b32 s34, 299008
  buffer_load_dwordx4 v252, s[44:47], s34 offen  lds
  v_mfma_f32_32x32x16_bf16 v[140:155], v[112:115], v[40:43], v[140:155]
  s_add_u32 m0, s32, 13312
  s_mov_b32 s34, 300032
  buffer_load_dwordx4 v252, s[44:47], s34 offen  lds
  v_mfma_f32_32x32x16_bf16 v[156:171], v[116:119], v[40:43], v[156:171]
  s_add_u32 m0, s32, 14336
  s_mov_b32 s34, 301056
  buffer_load_dwordx4 v252, s[44:47], s34 offen  lds
  v_mfma_f32_32x32x16_bf16 v[172:187], v[120:123], v[40:43], v[172:187]
  s_add_u32 m0, s32, 15360
  s_mov_b32 s34, 302080
  buffer_load_dwordx4 v252, s[44:47], s34 offen  lds
  ds_read_b128 v[92:95], v8 offset:16384
  ds_read_b128 v[96:99], v9 offset:16384
  ds_read_b128 v[100:103], v10 offset:16384
  ds_read_b128 v[104:107], v11 offset:16384
  ds_read_b128 v[108:111], v12 offset:16384
  ds_read_b128 v[112:115], v13 offset:16384
  ds_read_b128 v[116:119], v14 offset:16384
  ds_read_b128 v[120:123], v15 offset:16384
  s_waitcnt lgkmcnt(4)
  v_mfma_f32_32x32x16_bf16 v[44:59], v[92:95], v[60:63], 0
  v_mfma_f32_32x32x16_bf16 v[44:59], v[96:99], v[64:67], v[44:59]
  v_mfma_f32_32x32x16_bf16 v[44:59], v[100:103], v[68:71], v[44:59]
  v_mfma_f32_32x32x16_bf16 v[44:59], v[104:107], v[72:75], v[44:59]
  s_waitcnt lgkmcnt(0)
  v_mfma_f32_32x32x16_bf16 v[44:59], v[108:111], v[76:79], v[44:59]
  v_mfma_f32_32x32x16_bf16 v[44:59], v[112:115], v[80:83], v[44:59]
  v_mfma_f32_32x32x16_bf16 v[44:59], v[116:119], v[84:87], v[44:59]
  v_mfma_f32_32x32x16_bf16 v[44:59], v[120:123], v[88:91], v[44:59]
  s_mov_b32 s34, 327680
  buffer_load_dwordx4 v[60:63], v252, s[44:47], s34 offen offset:0
  s_mov_b32 s34, 327680
  buffer_load_dwordx4 v[64:67], v252, s[44:47], s34 offen offset:1024
  s_mov_b32 s34, 327680
  buffer_load_dwordx4 v[68:71], v252, s[44:47], s34 offen offset:2048
  s_mov_b32 s34, 327680
  buffer_load_dwordx4 v[72:75], v252, s[44:47], s34 offen offset:3072
  s_mov_b32 s34, 331776
  buffer_load_dwordx4 v[76:79], v252, s[44:47], s34 offen offset:0
  s_mov_b32 s34, 331776
  buffer_load_dwordx4 v[80:83], v252, s[44:47], s34 offen offset:1024
  s_mov_b32 s34, 331776
  buffer_load_dwordx4 v[84:87], v252, s[44:47], s34 offen offset:2048
  s_mov_b32 s34, 331776
  buffer_load_dwordx4 v[88:91], v252, s[44:47], s34 offen offset:3072
  v_max3_f32 v29, v44, v45, v46
  v_max3_f32 v30, v47, v48, v49
  v_max3_f32 v31, v50, v51, v52
  v_max3_f32 v32, v53, v54, v55
  v_max3_f32 v33, v56, v57, v58
  v_max3_f32 v29, v29, v30, v59
  v_max3_f32 v31, v31, v32, v33
  v_max_f32 v29, v29, v31
  v_mov_b32 v30, v29
  s_nop 1
  v_permlane32_swap_b32 v29, v30
  s_nop 1
  v_max3_f32 v29, v29, v30, v25
  v_mul_f32 v27, s36, v29
  v_fma_f32 v28, v25, s36, -v27
  v_mov_b32 v25, v29
  v_exp_f32 v28, v28
  v_fma_f32 v44, v44, s36, -v27
  v_fma_f32 v45, v45, s36, -v27
  v_fma_f32 v46, v46, s36, -v27
  v_fma_f32 v47, v47, s36, -v27
  v_fma_f32 v48, v48, s36, -v27
  v_fma_f32 v49, v49, s36, -v27
  v_fma_f32 v50, v50, s36, -v27
  v_fma_f32 v51, v51, s36, -v27
  v_fma_f32 v52, v52, s36, -v27
  v_fma_f32 v53, v53, s36, -v27
  v_fma_f32 v54, v54, s36, -v27
  v_fma_f32 v55, v55, s36, -v27
  v_fma_f32 v56, v56, s36, -v27
  v_fma_f32 v57, v57, s36, -v27
  v_fma_f32 v58, v58, s36, -v27
  v_fma_f32 v59, v59, s36, -v27
  v_exp_f32 v44, v44
  v_exp_f32 v45, v45
  v_exp_f32 v46, v46
  v_exp_f32 v47, v47
  v_exp_f32 v48, v48
  v_exp_f32 v49, v49
  v_exp_f32 v50, v50
  v_exp_f32 v51, v51
  v_exp_f32 v52, v52
  v_exp_f32 v53, v53
  v_exp_f32 v54, v54
  v_exp_f32 v55, v55
  v_exp_f32 v56, v56
  v_exp_f32 v57, v57
  v_exp_f32 v58, v58
  v_exp_f32 v59, v59
  v_mul_f32 v26, v26, v28
  v_add_f32 v29, v44, v48
  v_add_f32 v30, v45, v49
  v_add_f32 v31, v46, v50
  v_add_f32 v32, v47, v51
  v_add_f32 v29, v29, v52
  v_add_f32 v30, v30, v53
  v_add_f32 v31, v31, v54
  v_add_f32 v32, v32, v55
  v_add_f32 v29, v29, v56
  v_add_f32 v30, v30, v57
  v_add_f32 v31, v31, v58
  v_add_f32 v32, v32, v59
  v_add_f32 v29, v29, v30
  v_add_f32 v31, v31, v32
  v_cvt_pk_bf16_f32 v36, v44, v45
  v_cvt_pk_bf16_f32 v37, v46, v47
  v_cvt_pk_bf16_f32 v38, v48, v49
  v_cvt_pk_bf16_f32 v39, v50, v51
  v_cvt_pk_bf16_f32 v40, v52, v53
  v_cvt_pk_bf16_f32 v41, v54, v55
  v_cvt_pk_bf16_f32 v42, v56, v57
  v_cvt_pk_bf16_f32 v43, v58, v59
  v_add_f32 v26, v26, v29
  v_add_f32 v26, v26, v31
  v_mul_f32 v124, v124, v28
  v_mul_f32 v125, v125, v28
  v_mul_f32 v126, v126, v28
  v_mul_f32 v127, v127, v28
  v_mul_f32 v128, v128, v28
  v_mul_f32 v129, v129, v28
  v_mul_f32 v130, v130, v28
  v_mul_f32 v131, v131, v28
  v_mul_f32 v132, v132, v28
  v_mul_f32 v133, v133, v28
  v_mul_f32 v134, v134, v28
  v_mul_f32 v135, v135, v28
  v_mul_f32 v136, v136, v28
  v_mul_f32 v137, v137, v28
  v_mul_f32 v138, v138, v28
  v_mul_f32 v139, v139, v28
  v_mul_f32 v140, v140, v28
  v_mul_f32 v141, v141, v28
  v_mul_f32 v142, v142, v28
  v_mul_f32 v143, v143, v28
  v_mul_f32 v144, v144, v28
  v_mul_f32 v145, v145, v28
  v_mul_f32 v146, v146, v28
  v_mul_f32 v147, v147, v28
  v_mul_f32 v148, v148, v28
  v_mul_f32 v149, v149, v28
  v_mul_f32 v150, v150, v28
  v_mul_f32 v151, v151, v28
  v_mul_f32 v152, v152, v28
  v_mul_f32 v153, v153, v28
  v_mul_f32 v154, v154, v28
  v_mul_f32 v155, v155, v28
  v_mul_f32 v156, v156, v28
  v_mul_f32 v157, v157, v28
  v_mul_f32 v158, v158, v28
  v_mul_f32 v159, v159, v28
  v_mul_f32 v160, v160, v28
  v_mul_f32 v161, v161, v28
  v_mul_f32 v162, v162, v28
  v_mul_f32 v163, v163, v28
  v_mul_f32 v164, v164, v28
  v_mul_f32 v165, v165, v28
  v_mul_f32 v166, v166, v28
  v_mul_f32 v167, v167, v28
  v_mul_f32 v168, v168, v28
  v_mul_f32 v169, v169, v28
  v_mul_f32 v170, v170, v28
  v_mul_f32 v171, v171, v28
  v_mul_f32 v172, v172, v28
  v_mul_f32 v173, v173, v28
  v_mul_f32 v174, v174, v28
  v_mul_f32 v175, v175, v28
  v_mul_f32 v176, v176, v28
  v_mul_f32 v177, v177, v28
  v_mul_f32 v178, v178, v28
  v_mul_f32 v179, v179, v28
  v_mul_f32 v180, v180, v28
  v_mul_f32 v181, v181, v28
  v_mul_f32 v182, v182, v28
  v_mul_f32 v183, v183, v28
  v_mul_f32 v184, v184, v28
  v_mul_f32 v185, v185, v28
  v_mul_f32 v186, v186, v28
  v_mul_f32 v187, v187, v28
  v_mov_b32 v1, v26
  s_nop 1
  v_permlane32_swap_b32 v1, v26
  s_nop 1
  v_add_f32 v26, v26, v1
  v_and_b32 v2, 31, v0
  v_lshrrev_b32 v3, 5, v0
  v_lshlrev_b32 v4, 5, v2
  s_lshl_b32 s34, s20, 2
  v_add_u32 v4, s34, v4
  v_add_u32 v4, 147968, v4
  ds_write_b32 v4, v25
  ds_write_b32 v4, v26 offset:16
  v_lshlrev_b32 v4, 9, v2
  v_add_u32 v4, s32, v4
  v_and_b32 v5, 7, v2
  v_xor_b32 v5, v5, v3
  v_xor_b32 v6, 0, v5
  v_lshlrev_b32 v6, 4, v6
  v_add_u32 v29, v4, v6
  v_xor_b32 v6, 2, v5
  v_lshlrev_b32 v6, 4, v6
  v_add_u32 v30, v4, v6
  v_xor_b32 v6, 4, v5
  v_lshlrev_b32 v6, 4, v6
  v_add_u32 v31, v4, v6
  v_xor_b32 v6, 6, v5
  v_lshlrev_b32 v6, 4, v6
  v_add_u32 v32, v4, v6
  v_and_b32 v1, 8, v0
  v_mov_b32 v2, 0x4444
  v_mov_b32 v3, 0xeeee
  v_cmp_ne_u32 vcc, 0, v1
  s_nop 1
  v_cndmask_b32 v255, v2, v3, vcc
  s_lshl_b32 s34, s20, 6
  v_add_u32 v1, s34, v0
  v_lshrrev_b32 v2, 4, v1
  v_and_b32 v3, 15, v1
  v_lshlrev_b32 v52, 5, v2
  v_add_u32 v52, 147968, v52
  v_and_b32 v5, 7, v2
  v_xor_b32 v5, v5, v3
  v_lshlrev_b32 v5, 4, v5
  v_lshlrev_b32 v6, 9, v2
  v_add_u32 v5, v5, v6
  v_add_u32 v53, 16384, v5
  v_add_u32 v54, 65536, v53
  v_and_b32 v4, 7, v2
  v_mul_u32_u24 v4, 544, v4
  v_lshrrev_b32 v5, 3, v2
  v_lshlrev_b32 v5, 7, v5
  v_add_u32 v4, v4, v5
  v_lshlrev_b32 v5, 2, v3
  v_add_u32 v4, v4, v5
  v_add_u32 v55, 139264, v4
  s_waitcnt vmcnt(20)
  ds_read_b64_tr_b16 v[92:93], v16 offset:16384
  ds_read_b64_tr_b16 v[94:95], v16 offset:18432
  ds_read_b64_tr_b16 v[96:97], v17 offset:16384
  ds_read_b64_tr_b16 v[98:99], v17 offset:18432
  ds_read_b64_tr_b16 v[100:101], v18 offset:16384
  ds_read_b64_tr_b16 v[102:103], v18 offset:18432
  ds_read_b64_tr_b16 v[104:105], v19 offset:16384
  ds_read_b64_tr_b16 v[106:107], v19 offset:18432
  ds_read_b64_tr_b16 v[108:109], v16 offset:20480
  ds_read_b64_tr_b16 v[110:111], v16 offset:22528
  ds_read_b64_tr_b16 v[112:113], v17 offset:20480
  ds_read_b64_tr_b16 v[114:115], v17 offset:22528
  ds_read_b64_tr_b16 v[116:117], v18 offset:20480
  ds_read_b64_tr_b16 v[118:119], v18 offset:22528
  ds_read_b64_tr_b16 v[120:121], v19 offset:20480
  ds_read_b64_tr_b16 v[122:123], v19 offset:22528
  s_waitcnt lgkmcnt(0)
  v_mfma_f32_32x32x16_bf16 v[124:139], v[92:95], v[36:39], v[124:139]
  v_mfma_f32_32x32x16_bf16 v[140:155], v[96:99], v[36:39], v[140:155]
  v_mfma_f32_32x32x16_bf16 v[156:171], v[100:103], v[36:39], v[156:171]
  v_mfma_f32_32x32x16_bf16 v[172:187], v[104:107], v[36:39], v[172:187]
  v_mfma_f32_32x32x16_bf16 v[124:139], v[108:111], v[40:43], v[124:139]
  v_mfma_f32_32x32x16_bf16 v[140:155], v[112:115], v[40:43], v[140:155]
  v_mfma_f32_32x32x16_bf16 v[156:171], v[116:119], v[40:43], v[156:171]
  v_mfma_f32_32x32x16_bf16 v[172:187], v[120:123], v[40:43], v[172:187]
  s_mov_b32 s34, 360448
  buffer_load_dwordx4 v[92:95], v252, s[44:47], s34 offen offset:0
  s_mov_b32 s34, 360448
  buffer_load_dwordx4 v[96:99], v252, s[44:47], s34 offen offset:1024
  s_mov_b32 s34, 360448
  buffer_load_dwordx4 v[100:103], v252, s[44:47], s34 offen offset:2048
  s_mov_b32 s34, 360448
  buffer_load_dwordx4 v[104:107], v252, s[44:47], s34 offen offset:3072
  s_mov_b32 s34, 364544
  buffer_load_dwordx4 v[108:111], v252, s[44:47], s34 offen offset:0
  s_mov_b32 s34, 364544
  buffer_load_dwordx4 v[112:115], v252, s[44:47], s34 offen offset:1024
  s_mov_b32 s34, 364544
  buffer_load_dwordx4 v[116:119], v252, s[44:47], s34 offen offset:2048
  s_mov_b32 s34, 364544
  buffer_load_dwordx4 v[120:123], v252, s[44:47], s34 offen offset:3072
  ds_write_b128 v29, v[124:127] offset:16384
  ds_write_b128 v30, v[128:131] offset:16384
  ds_write_b128 v31, v[132:135] offset:16384
  ds_write_b128 v32, v[136:139] offset:16384
  ds_write_b128 v29, v[140:143] offset:16512
  ds_write_b128 v30, v[144:147] offset:16512
  ds_write_b128 v31, v[148:151] offset:16512
  ds_write_b128 v32, v[152:155] offset:16512
  ds_write_b128 v29, v[156:159] offset:16640
  ds_write_b128 v30, v[160:163] offset:16640
  ds_write_b128 v31, v[164:167] offset:16640
  ds_write_b128 v32, v[168:171] offset:16640
  ds_write_b128 v29, v[172:175] offset:16768
  ds_write_b128 v30, v[176:179] offset:16768
  ds_write_b128 v31, v[180:183] offset:16768
  ds_write_b128 v32, v[184:187] offset:16768
  s_waitcnt lgkmcnt(0)
  s_mov_b32 s34, 393216
  buffer_load_dwordx4 v[124:127], v252, s[44:47], s34 offen offset:0
  s_mov_b32 s34, 393216
  buffer_load_dwordx4 v[128:131], v252, s[44:47], s34 offen offset:1024
  s_mov_b32 s34, 393216
  buffer_load_dwordx4 v[132:135], v252, s[44:47], s34 offen offset:2048
  s_mov_b32 s34, 393216
  buffer_load_dwordx4 v[136:139], v252, s[44:47], s34 offen offset:3072
  s_mov_b32 s34, 397312
  buffer_load_dwordx4 v[140:143], v252, s[44:47], s34 offen offset:0
  s_mov_b32 s34, 397312
  buffer_load_dwordx4 v[144:147], v252, s[44:47], s34 offen offset:1024
  s_mov_b32 s34, 397312
  buffer_load_dwordx4 v[148:151], v252, s[44:47], s34 offen offset:2048
  s_mov_b32 s34, 397312
  buffer_load_dwordx4 v[152:155], v252, s[44:47], s34 offen offset:3072
  s_barrier
  ds_read_b128 v[8:11], v52
  ds_read_b128 v[12:15], v52 offset:16
  ds_read_b128 v[16:19], v53 offset:0
  ds_read_b128 v[20:23], v53 offset:256
  ds_read_b128 v[24:27], v53 offset:32768
  ds_read_b128 v[28:31], v53 offset:33024
  ds_read_b128 v[32:35], v54 offset:0
  ds_read_b128 v[36:39], v54 offset:256
  ds_read_b128 v[40:43], v54 offset:32768
  ds_read_b128 v[44:47], v54 offset:33024
  s_mov_b32 s34, 425984
  buffer_load_dwordx4 v[156:159], v252, s[44:47], s34 offen offset:0
  s_mov_b32 s34, 425984
  buffer_load_dwordx4 v[160:163], v252, s[44:47], s34 offen offset:1024
  s_mov_b32 s34, 425984
  buffer_load_dwordx4 v[164:167], v252, s[44:47], s34 offen offset:2048
  s_mov_b32 s34, 425984
  buffer_load_dwordx4 v[168:171], v252, s[44:47], s34 offen offset:3072
  s_mov_b32 s34, 430080
  buffer_load_dwordx4 v[172:175], v252, s[44:47], s34 offen offset:0
  s_mov_b32 s34, 430080
  buffer_load_dwordx4 v[176:179], v252, s[44:47], s34 offen offset:1024
  s_mov_b32 s34, 430080
  buffer_load_dwordx4 v[180:183], v252, s[44:47], s34 offen offset:2048
  s_mov_b32 s34, 430080
  buffer_load_dwordx4 v[184:187], v252, s[44:47], s34 offen offset:3072
  s_waitcnt lgkmcnt(8)
  v_max3_f32 v48, v8, v9, v10
  v_max_f32 v48, v48, v11
  v_sub_f32 v8, v8, v48
  v_sub_f32 v9, v9, v48
  v_sub_f32 v10, v10, v48
  v_sub_f32 v11, v11, v48
  v_mul_f32 v8, s36, v8
  v_mul_f32 v9, s36, v9
  v_mul_f32 v10, s36, v10
  v_mul_f32 v11, s36, v11
  v_exp_f32 v8, v8
  v_exp_f32 v9, v9
  v_exp_f32 v10, v10
  v_exp_f32 v11, v11
  s_nop 0
  v_mul_f32 v48, v8, v12
  v_fmac_f32 v48, v9, v13
  v_fmac_f32 v48, v10, v14
  v_fmac_f32 v48, v11, v15
  v_rcp_f32 v48, v48
  s_nop 0
  v_mul_f32 v8, v8, v48
  v_mul_f32 v9, v9, v48
  v_mul_f32 v10, v10, v48
  v_mul_f32 v11, v11, v48
  s_waitcnt lgkmcnt(0)
  v_mul_f32 v16, v8, v16
  v_mul_f32 v17, v8, v17
  v_mul_f32 v18, v8, v18
  v_mul_f32 v19, v8, v19
  v_mul_f32 v20, v8, v20
  v_mul_f32 v21, v8, v21
  v_mul_f32 v22, v8, v22
  v_mul_f32 v23, v8, v23
  v_fmac_f32 v16, v9, v24
  v_fmac_f32 v17, v9, v25
  v_fmac_f32 v18, v9, v26
  v_fmac_f32 v19, v9, v27
  v_fmac_f32 v20, v9, v28
  v_fmac_f32 v21, v9, v29
  v_fmac_f32 v22, v9, v30
  v_fmac_f32 v23, v9, v31
  v_fmac_f32 v16, v10, v32
  v_fmac_f32 v17, v10, v33
  v_fmac_f32 v18, v10, v34
  v_fmac_f32 v19, v10, v35
  v_fmac_f32 v20, v10, v36
  v_fmac_f32 v21, v10, v37
  v_fmac_f32 v22, v10, v38
  v_fmac_f32 v23, v10, v39
  v_fmac_f32 v16, v11, v40
  v_fmac_f32 v17, v11, v41
  v_fmac_f32 v18, v11, v42
  v_fmac_f32 v19, v11, v43
  v_fmac_f32 v20, v11, v44
  v_fmac_f32 v21, v11, v45
  v_fmac_f32 v22, v11, v46
  v_fmac_f32 v23, v11, v47
  v_cvt_pk_bf16_f32 v48, v16, v17
  v_cvt_pk_bf16_f32 v49, v18, v19
  v_cvt_pk_bf16_f32 v50, v20, v21
  v_cvt_pk_bf16_f32 v51, v22, v23
  ds_write2_b32 v55, v48, v50 offset1:16
  v_add_u32 v55, 4352, v55
  ds_write2_b32 v55, v49, v51 offset1:16
  v_mov_b32 v8, 0
  v_mov_b32 v9, 0
  v_mov_b32 v10, 0
  v_mov_b32 v11, 0
  v_mov_b32 v12, 0
  v_mov_b32 v13, 0
  v_mov_b32 v14, 0
  v_mov_b32 v15, 0
  v_mov_b32 v16, 0
  v_mov_b32 v17, 0
  v_mov_b32 v18, 0
  v_mov_b32 v19, 0
  v_mov_b32 v20, 0
  v_mov_b32 v21, 0
  v_mov_b32 v22, 0
  v_mov_b32 v23, 0
  v_mov_b32 v24, 0
  v_mov_b32 v25, 0
  v_mov_b32 v26, 0
  v_mov_b32 v27, 0
  v_mov_b32 v28, 0
  v_mov_b32 v29, 0
  v_mov_b32 v30, 0
  v_mov_b32 v31, 0
  v_mov_b32 v32, 0
  v_mov_b32 v33, 0
  v_mov_b32 v34, 0
  v_mov_b32 v35, 0
  v_mov_b32 v36, 0
  v_mov_b32 v37, 0
  v_mov_b32 v38, 0
  v_mov_b32 v39, 0
  s_waitcnt lgkmcnt(0)
  s_barrier
  s_setprio 1
  ds_read_b128 v[40:43], v253 offset:192
  ds_read_b128 v[44:47], v253 offset:320
  s_waitcnt lgkmcnt(1)
  v_smfmac_f32_16x16x64_bf16 v[8:11], v[40:43], v[188:195], v255
  v_smfmac_f32_16x16x64_bf16 v[12:15], v[40:43], v[196:203], v255
  v_smfmac_f32_16x16x64_bf16 v[16:19], v[40:43], v[204:211], v255
  v_smfmac_f32_16x16x64_bf16 v[20:23], v[40:43], v[212:219], v255
  v_smfmac_f32_16x16x64_bf16 v[24:27], v[40:43], v[220:227], v255
  v_smfmac_f32_16x16x64_bf16 v[28:31], v[40:43], v[228:235], v255
  v_smfmac_f32_16x16x64_bf16 v[32:35], v[40:43], v[236:243], v255
  v_smfmac_f32_16x16x64_bf16 v[36:39], v[40:43], v[244:251], v255
  s_waitcnt vmcnt(32)
  ds_read_b128 v[188:191], v254 offset:0
  ds_read_b128 v[192:195], v254 offset:1024
  ds_read_b128 v[196:199], v254 offset:2048
  ds_read_b128 v[200:203], v254 offset:3072
  ds_read_b128 v[204:207], v254 offset:4096
  ds_read_b128 v[208:211], v254 offset:5120
  ds_read_b128 v[212:215], v254 offset:6144
  ds_read_b128 v[216:219], v254 offset:7168
  ds_read_b128 v[220:223], v254 offset:8192
  ds_read_b128 v[224:227], v254 offset:9216
  ds_read_b128 v[228:231], v254 offset:10240
  ds_read_b128 v[232:235], v254 offset:11264
  ds_read_b128 v[236:239], v254 offset:12288
  ds_read_b128 v[240:243], v254 offset:13312
  ds_read_b128 v[244:247], v254 offset:14336
  ds_read_b128 v[248:251], v254 offset:15360
  ds_read_b128 v[40:43], v253 offset:256
  s_waitcnt vmcnt(16)
  s_waitcnt lgkmcnt(15)
  v_perm_b32 v48, v64, v60, s40
  v_perm_b32 v49, v72, v68, s40
  v_perm_b32 v50, v80, v76, s40
  v_perm_b32 v51, v88, v84, s40
  v_perm_b32 v52, v96, v92, s40
  v_perm_b32 v53, v104, v100, s40
  v_perm_b32 v54, v112, v108, s40
  v_perm_b32 v55, v120, v116, s40
  v_perm_b32 v0, v64, v60, s41
  v_perm_b32 v1, v72, v68, s41
  v_perm_b32 v2, v80, v76, s41
  v_perm_b32 v3, v88, v84, s41
  v_perm_b32 v4, v96, v92, s41
  v_perm_b32 v5, v104, v100, s41
  v_perm_b32 v6, v112, v108, s41
  v_perm_b32 v7, v120, v116, s41
  v_smfmac_f32_16x16x64_bf16 v[8:11], v[44:47], v[48:55], v255
  v_perm_b32 v48, v65, v61, s40
  v_perm_b32 v49, v73, v69, s40
  v_perm_b32 v50, v81, v77, s40
  v_perm_b32 v51, v89, v85, s40
  v_perm_b32 v52, v97, v93, s40
  v_perm_b32 v53, v105, v101, s40
  v_perm_b32 v54, v113, v109, s40
  v_perm_b32 v55, v121, v117, s40
  v_smfmac_f32_16x16x64_bf16 v[12:15], v[44:47], v[0:7], v255
  v_perm_b32 v0, v65, v61, s41
  v_perm_b32 v1, v73, v69, s41
  v_perm_b32 v2, v81, v77, s41
  v_perm_b32 v3, v89, v85, s41
  v_perm_b32 v4, v97, v93, s41
  v_perm_b32 v5, v105, v101, s41
  v_perm_b32 v6, v113, v109, s41
  v_perm_b32 v7, v121, v117, s41
  v_smfmac_f32_16x16x64_bf16 v[16:19], v[44:47], v[48:55], v255
  v_perm_b32 v48, v66, v62, s40
  v_perm_b32 v49, v74, v70, s40
  v_perm_b32 v50, v82, v78, s40
  v_perm_b32 v51, v90, v86, s40
  v_perm_b32 v52, v98, v94, s40
  v_perm_b32 v53, v106, v102, s40
  v_perm_b32 v54, v114, v110, s40
  v_perm_b32 v55, v122, v118, s40
  v_smfmac_f32_16x16x64_bf16 v[20:23], v[44:47], v[0:7], v255
  v_perm_b32 v0, v66, v62, s41
  v_perm_b32 v1, v74, v70, s41
  v_perm_b32 v2, v82, v78, s41
  v_perm_b32 v3, v90, v86, s41
  v_perm_b32 v4, v98, v94, s41
  v_perm_b32 v5, v106, v102, s41
  v_perm_b32 v6, v114, v110, s41
  v_perm_b32 v7, v122, v118, s41
  v_smfmac_f32_16x16x64_bf16 v[24:27], v[44:47], v[48:55], v255
  v_perm_b32 v48, v67, v63, s40
  v_perm_b32 v49, v75, v71, s40
  v_perm_b32 v50, v83, v79, s40
  v_perm_b32 v51, v91, v87, s40
  v_perm_b32 v52, v99, v95, s40
  v_perm_b32 v53, v107, v103, s40
  v_perm_b32 v54, v115, v111, s40
  v_perm_b32 v55, v123, v119, s40
  v_smfmac_f32_16x16x64_bf16 v[28:31], v[44:47], v[0:7], v255
  v_perm_b32 v0, v67, v63, s41
  v_perm_b32 v1, v75, v71, s41
  v_perm_b32 v2, v83, v79, s41
  v_perm_b32 v3, v91, v87, s41
  v_perm_b32 v4, v99, v95, s41
  v_perm_b32 v5, v107, v103, s41
  v_perm_b32 v6, v115, v111, s41
  v_perm_b32 v7, v123, v119, s41
  v_smfmac_f32_16x16x64_bf16 v[32:35], v[44:47], v[48:55], v255
  s_nop 0
  v_smfmac_f32_16x16x64_bf16 v[36:39], v[44:47], v[0:7], v255
  ds_read_b128 v[44:47], v253 offset:384
  s_waitcnt lgkmcnt(1)
  v_perm_b32 v48, v192, v188, s40
  v_perm_b32 v49, v200, v196, s40
  v_perm_b32 v50, v208, v204, s40
  v_perm_b32 v51, v216, v212, s40
  v_perm_b32 v52, v224, v220, s40
  v_perm_b32 v53, v232, v228, s40
  v_perm_b32 v54, v240, v236, s40
  v_perm_b32 v55, v248, v244, s40
  v_perm_b32 v0, v192, v188, s41
  v_perm_b32 v1, v200, v196, s41
  v_perm_b32 v2, v208, v204, s41
  v_perm_b32 v3, v216, v212, s41
  v_perm_b32 v4, v224, v220, s41
  v_perm_b32 v5, v232, v228, s41
  v_perm_b32 v6, v240, v236, s41
  v_perm_b32 v7, v248, v244, s41
  v_smfmac_f32_16x16x64_bf16 v[8:11], v[40:43], v[48:55], v255
  v_perm_b32 v48, v193, v189, s40
  v_perm_b32 v49, v201, v197, s40
  v_perm_b32 v50, v209, v205, s40
  v_perm_b32 v51, v217, v213, s40
  v_perm_b32 v52, v225, v221, s40
  v_perm_b32 v53, v233, v229, s40
  v_perm_b32 v54, v241, v237, s40
  v_perm_b32 v55, v249, v245, s40
  v_smfmac_f32_16x16x64_bf16 v[12:15], v[40:43], v[0:7], v255
  v_perm_b32 v0, v193, v189, s41
  v_perm_b32 v1, v201, v197, s41
  v_perm_b32 v2, v209, v205, s41
  v_perm_b32 v3, v217, v213, s41
  v_perm_b32 v4, v225, v221, s41
  v_perm_b32 v5, v233, v229, s41
  v_perm_b32 v6, v241, v237, s41
  v_perm_b32 v7, v249, v245, s41
  v_smfmac_f32_16x16x64_bf16 v[16:19], v[40:43], v[48:55], v255
  v_perm_b32 v48, v194, v190, s40
  v_perm_b32 v49, v202, v198, s40
  v_perm_b32 v50, v210, v206, s40
  v_perm_b32 v51, v218, v214, s40
  v_perm_b32 v52, v226, v222, s40
  v_perm_b32 v53, v234, v230, s40
  v_perm_b32 v54, v242, v238, s40
  v_perm_b32 v55, v250, v246, s40
  v_smfmac_f32_16x16x64_bf16 v[20:23], v[40:43], v[0:7], v255
  v_perm_b32 v0, v194, v190, s41
  v_perm_b32 v1, v202, v198, s41
  v_perm_b32 v2, v210, v206, s41
  v_perm_b32 v3, v218, v214, s41
  v_perm_b32 v4, v226, v222, s41
  v_perm_b32 v5, v234, v230, s41
  v_perm_b32 v6, v242, v238, s41
  v_perm_b32 v7, v250, v246, s41
  v_smfmac_f32_16x16x64_bf16 v[24:27], v[40:43], v[48:55], v255
  v_perm_b32 v48, v195, v191, s40
  v_perm_b32 v49, v203, v199, s40
  v_perm_b32 v50, v211, v207, s40
  v_perm_b32 v51, v219, v215, s40
  v_perm_b32 v52, v227, v223, s40
  v_perm_b32 v53, v235, v231, s40
  v_perm_b32 v54, v243, v239, s40
  v_perm_b32 v55, v251, v247, s40
  v_smfmac_f32_16x16x64_bf16 v[28:31], v[40:43], v[0:7], v255
  v_perm_b32 v0, v195, v191, s41
  v_perm_b32 v1, v203, v199, s41
  v_perm_b32 v2, v211, v207, s41
  v_perm_b32 v3, v219, v215, s41
  v_perm_b32 v4, v227, v223, s41
  v_perm_b32 v5, v235, v231, s41
  v_perm_b32 v6, v243, v239, s41
  v_perm_b32 v7, v251, v247, s41
  v_smfmac_f32_16x16x64_bf16 v[32:35], v[40:43], v[48:55], v255
  s_nop 0
  v_smfmac_f32_16x16x64_bf16 v[36:39], v[40:43], v[0:7], v255
  s_waitcnt vmcnt(0)
  s_waitcnt lgkmcnt(0)
  v_perm_b32 v48, v128, v124, s40
  v_perm_b32 v49, v136, v132, s40
  v_perm_b32 v50, v144, v140, s40
  v_perm_b32 v51, v152, v148, s40
  v_perm_b32 v52, v160, v156, s40
  v_perm_b32 v53, v168, v164, s40
  v_perm_b32 v54, v176, v172, s40
  v_perm_b32 v55, v184, v180, s40
  v_perm_b32 v0, v128, v124, s41
  v_perm_b32 v1, v136, v132, s41
  v_perm_b32 v2, v144, v140, s41
  v_perm_b32 v3, v152, v148, s41
  v_perm_b32 v4, v160, v156, s41
  v_perm_b32 v5, v168, v164, s41
  v_perm_b32 v6, v176, v172, s41
  v_perm_b32 v7, v184, v180, s41
  v_smfmac_f32_16x16x64_bf16 v[8:11], v[44:47], v[48:55], v255
  v_perm_b32 v48, v129, v125, s40
  v_perm_b32 v49, v137, v133, s40
  v_perm_b32 v50, v145, v141, s40
  v_perm_b32 v51, v153, v149, s40
  v_perm_b32 v52, v161, v157, s40
  v_perm_b32 v53, v169, v165, s40
  v_perm_b32 v54, v177, v173, s40
  v_perm_b32 v55, v185, v181, s40
  v_smfmac_f32_16x16x64_bf16 v[12:15], v[44:47], v[0:7], v255
  v_perm_b32 v0, v129, v125, s41
  v_perm_b32 v1, v137, v133, s41
  v_perm_b32 v2, v145, v141, s41
  v_perm_b32 v3, v153, v149, s41
  v_perm_b32 v4, v161, v157, s41
  v_perm_b32 v5, v169, v165, s41
  v_perm_b32 v6, v177, v173, s41
  v_perm_b32 v7, v185, v181, s41
  v_smfmac_f32_16x16x64_bf16 v[16:19], v[44:47], v[48:55], v255
  v_perm_b32 v48, v130, v126, s40
  v_perm_b32 v49, v138, v134, s40
  v_perm_b32 v50, v146, v142, s40
  v_perm_b32 v51, v154, v150, s40
  v_perm_b32 v52, v162, v158, s40
  v_perm_b32 v53, v170, v166, s40
  v_perm_b32 v54, v178, v174, s40
  v_perm_b32 v55, v186, v182, s40
  v_smfmac_f32_16x16x64_bf16 v[20:23], v[44:47], v[0:7], v255
  v_perm_b32 v0, v130, v126, s41
  v_perm_b32 v1, v138, v134, s41
  v_perm_b32 v2, v146, v142, s41
  v_perm_b32 v3, v154, v150, s41
  v_perm_b32 v4, v162, v158, s41
  v_perm_b32 v5, v170, v166, s41
  v_perm_b32 v6, v178, v174, s41
  v_perm_b32 v7, v186, v182, s41
  v_smfmac_f32_16x16x64_bf16 v[24:27], v[44:47], v[48:55], v255
  v_perm_b32 v48, v131, v127, s40
  v_perm_b32 v49, v139, v135, s40
  v_perm_b32 v50, v147, v143, s40
  v_perm_b32 v51, v155, v151, s40
  v_perm_b32 v52, v163, v159, s40
  v_perm_b32 v53, v171, v167, s40
  v_perm_b32 v54, v179, v175, s40
  v_perm_b32 v55, v187, v183, s40
  v_smfmac_f32_16x16x64_bf16 v[28:31], v[44:47], v[0:7], v255
  v_perm_b32 v0, v131, v127, s41
  v_perm_b32 v1, v139, v135, s41
  v_perm_b32 v2, v147, v143, s41
  v_perm_b32 v3, v155, v151, s41
  v_perm_b32 v4, v163, v159, s41
  v_perm_b32 v5, v171, v167, s41
  v_perm_b32 v6, v179, v175, s41
  v_perm_b32 v7, v187, v183, s41
  v_smfmac_f32_16x16x64_bf16 v[32:35], v[44:47], v[48:55], v255
  s_nop 0
  v_smfmac_f32_16x16x64_bf16 v[36:39], v[44:47], v[0:7], v255
  s_nop 7
  ds_write_b128 v254, v[8:11] offset:16384
  ds_write_b128 v254, v[12:15] offset:17408
  ds_write_b128 v254, v[16:19] offset:18432
  ds_write_b128 v254, v[20:23] offset:19456
  ds_write_b128 v254, v[24:27] offset:20480
  ds_write_b128 v254, v[28:31] offset:21504
  ds_write_b128 v254, v[32:35] offset:22528
  ds_write_b128 v254, v[36:39] offset:23552
  s_waitcnt lgkmcnt(0)
  s_barrier
  s_endpgm
L_pwave:
  s_mov_b32 s3, 1
  s_setprio 3
  s_lshr_b32 s42, s22, 2
  s_and_b32 s43, s22, 3
  s_and_b32 s39, s42, 3
  s_mov_b32 s28, s4
  s_and_b32 s29, s5, 0xffff
  s_mov_b32 s30, 262144
  s_mov_b32 s31, 0x20000
  v_and_b32 v2, 15, v0
  v_lshrrev_b32 v3, 4, v0
  v_lshlrev_b32 v4, 10, v2
  v_lshlrev_b32 v5, 4, v3
  v_add_u32 v9, v4, v5
  v_lshlrev_b32 v4, 16, v3
  v_lshlrev_b32 v5, 4, v2
  v_add_u32 v8, v4, v5
  s_lshl_b32 s34, s21, 2
  s_add_u32 s34, s34, s43
  s_lshl_b32 s34, s34, 8
  s_add_u32 s24, s10, s34
  s_addc_u32 s25, s11, 0
  s_and_b32 s25, s25, 0xffff
  s_sub_u32 s26, 4194304, s34
  s_mov_b32 s27, 0x20000
  s_add_u32 s48, s39, 0
  s_and_b32 s48, s48, 3
  s_add_u32 s49, s39, 1
  s_and_b32 s49, s49, 3
  s_add_u32 s50, s39, 2
  s_and_b32 s50, s50, 3
  s_add_u32 s51, s39, 3
  s_and_b32 s51, s51, 3
  s_and_b32 s34, s23, 1
  s_lshl_b32 s52, s42, 15
  s_lshl_b32 s38, s34, 14
  s_add_u32 s52, s52, s38
  s_lshl_b32 s38, s23, 8
  s_add_u32 s52, s52, s38
  s_xor_b32 s53, s52, 16384
  v_lshrrev_b32 v2, 4, v0
  v_and_b32 v3, 15, v0
  v_xor_b32 v4, v2, v3
  v_lshlrev_b32 v5, 10, v2
  v_xor_b32 v6, 0, v4
  v_lshlrev_b32 v6, 4, v6
  v_add_u32 v248, v5, v6
  v_xor_b32 v6, 4, v4
  v_lshlrev_b32 v6, 4, v6
  v_add_u32 v249, v5, v6
  v_xor_b32 v6, 8, v4
  v_lshlrev_b32 v6, 4, v6
  v_add_u32 v250, v5, v6
  v_xor_b32 v6, 12, v4
  v_lshlrev_b32 v6, 4, v6
  v_add_u32 v251, v5, v6
  s_lshl_b32 s52, s42, 15
  s_lshl_b32 s38, s23, 8
  s_add_u32 s52, s52, s38
  s_lshl_b32 s53, s23, 15
  s_add_u32 s53, s53, 24576
  s_add_u32 m0, s53, 0
  s_add_u32 s34, s52, 0
  buffer_load_dwordx4 v248, s[28:31], s34 offen  lds
  s_add_u32 m0, s53, 1024
  s_add_u32 s34, s52, 4096
  buffer_load_dwordx4 v249, s[28:31], s34 offen  lds
  s_add_u32 m0, s53, 2048
  s_add_u32 s34, s52, 8192
  buffer_load_dwordx4 v250, s[28:31], s34 offen  lds
  s_add_u32 m0, s53, 3072
  s_add_u32 s34, s52, 12288
  buffer_load_dwordx4 v251, s[28:31], s34 offen  lds
  s_add_u32 m0, s53, 4096
  s_add_u32 s34, s52, 16384
  buffer_load_dwordx4 v248, s[28:31], s34 offen  lds
  s_add_u32 m0, s53, 5120
  s_add_u32 s34, s52, 20480
  buffer_load_dwordx4 v249, s[28:31], s34 offen  lds
  s_add_u32 m0, s53, 6144
  s_add_u32 s34, s52, 24576
  buffer_load_dwordx4 v250, s[28:31], s34 offen  lds
  s_add_u32 m0, s53, 7168
  s_add_u32 s34, s52, 28672
  buffer_load_dwordx4 v251, s[28:31], s34 offen  lds
  s_lshl_b32 s38, s23, 2
  s_add_u32 s38, s38, s48
  s_lshl_b32 s38, s38, 18
  s_add_u32 s34, s38, 0
  buffer_load_dwordx4 v[120:123], v8, s[24:27], s34 offen
  s_add_u32 s34, s38, 8192
  buffer_load_dwordx4 v[124:127], v8, s[24:27], s34 offen
  s_add_u32 s34, s38, 16384
  buffer_load_dwordx4 v[128:131], v8, s[24:27], s34 offen
  s_add_u32 s34, s38, 24576
  buffer_load_dwordx4 v[132:135], v8, s[24:27], s34 offen
  s_add_u32 s34, s38, 32768
  buffer_load_dwordx4 v[136:139], v8, s[24:27], s34 offen
  s_add_u32 s34, s38, 40960
  buffer_load_dwordx4 v[140:143], v8, s[24:27], s34 offen
  s_add_u32 s34, s38, 49152
  buffer_load_dwordx4 v[144:147], v8, s[24:27], s34 offen
  v_and_b32 v2, 15, v0
  v_lshrrev_b32 v3, 4, v0
  v_and_b32 v4, 3, v2
  v_xor_b32 v4, v4, v3
  v_lshlrev_b32 v4, 4, v4
  v_lshlrev_b32 v5, 8, v2
  s_add_u32 s34, s38, 57344
  buffer_load_dwordx4 v[148:151], v8, s[24:27], s34 offen
  v_add_u32 v4, v4, v5
  s_and_b32 s92, s23, 1
  s_lshl_b32 s92, s92, 12
  s_add_u32 s92, s92, s53
  v_add_u32 v4, s92, v4
  v_lshrrev_b32 v5, 2, v2
  s_lshl_b32 s38, s23, 2
  s_add_u32 s38, s38, s49
  s_lshl_b32 s38, s38, 18
  s_add_u32 s34, s38, 0
  buffer_load_dwordx4 v[152:155], v8, s[24:27], s34 offen
  v_xor_b32 v6, s48, v5
  v_lshlrev_b32 v6, 6, v6
  v_add_u32 v248, v4, v6
  v_xor_b32 v6, s49, v5
  v_lshlrev_b32 v6, 6, v6
  v_add_u32 v249, v4, v6
  s_add_u32 s34, s38, 8192
  buffer_load_dwordx4 v[156:159], v8, s[24:27], s34 offen
  v_xor_b32 v6, s50, v5
  v_lshlrev_b32 v6, 6, v6
  v_add_u32 v250, v4, v6
  v_xor_b32 v6, s51, v5
  v_lshlrev_b32 v6, 6, v6
  v_add_u32 v251, v4, v6
  s_add_u32 s34, s38, 16384
  buffer_load_dwordx4 v[160:163], v8, s[24:27], s34 offen
  s_sub_u32 s54, s23, 1
  s_cmp_lt_u32 s23, 2
  s_cselect_b32 s54, 0, s54
  s_and_b32 s55, s23, 1
  s_xor_b32 s56, s55, 1
  v_lshlrev_b32 v10, 4, v0
  s_mul_i32 s57, s56, 3
  s_add_u32 s34, s38, 24576
  buffer_load_dwordx4 v[164:167], v8, s[24:27], s34 offen
  s_add_u32 s57, s57, s54
  s_lshl_b32 s92, s57, 15
  s_add_u32 s92, s92, 24576
  s_sub_u32 s93, s57, 4
  s_lshl_b32 s93, s93, 13
  s_add_u32 s93, s93, 131072
  s_add_u32 s34, s38, 32768
  buffer_load_dwordx4 v[168:171], v8, s[24:27], s34 offen
  s_cmp_lt_u32 s57, 4
  s_cselect_b32 s57, s92, s93
  v_add_u32 v52, s57, v10
  s_mul_i32 s57, s55, 3
  s_add_u32 s57, s57, s54
  s_lshl_b32 s92, s57, 15
  s_add_u32 s92, s92, 24576
  s_add_u32 s34, s38, 40960
  buffer_load_dwordx4 v[172:175], v8, s[24:27], s34 offen
  s_sub_u32 s93, s57, 4
  s_lshl_b32 s93, s93, 13
  s_add_u32 s93, s93, 131072
  s_cmp_lt_u32 s57, 4
  s_cselect_b32 s57, s92, s93
  v_add_u32 v53, s57, v10
  s_mov_b32 s58, 0
  s_add_u32 s34, s38, 49152
  buffer_load_dwordx4 v[176:179], v8, s[24:27], s34 offen
  s_mul_i32 s57, s55, 3
  s_add_u32 s57, s57, s58
  s_lshl_b32 s92, s57, 15
  s_add_u32 s92, s92, 24576
  s_sub_u32 s93, s57, 4
  s_lshl_b32 s93, s93, 13
  s_add_u32 s34, s38, 57344
  buffer_load_dwordx4 v[180:183], v8, s[24:27], s34 offen
  s_add_u32 s93, s93, 131072
  s_cmp_lt_u32 s57, 4
  s_cselect_b32 s57, s92, s93
  v_add_u32 v54, s57, v10
  s_mov_b32 s58, 1
  s_mul_i32 s57, s55, 3
  s_add_u32 s57, s57, s58
  s_lshl_b32 s38, s23, 2
  s_add_u32 s38, s38, s50
  s_lshl_b32 s38, s38, 18
  s_add_u32 s34, s38, 0
  buffer_load_dwordx4 v[184:187], v8, s[24:27], s34 offen
  s_lshl_b32 s92, s57, 15
  s_add_u32 s92, s92, 24576
  s_sub_u32 s93, s57, 4
  s_lshl_b32 s93, s93, 13
  s_add_u32 s93, s93, 131072
  s_cmp_lt_u32 s57, 4
  s_cselect_b32 s57, s92, s93
  s_add_u32 s34, s38, 8192
  buffer_load_dwordx4 v[188:191], v8, s[24:27], s34 offen
  v_add_u32 v55, s57, v10
  s_mov_b32 s58, 2
  s_mul_i32 s57, s55, 3
  s_add_u32 s57, s57, s58
  s_lshl_b32 s92, s57, 15
  s_add_u32 s92, s92, 24576
  s_add_u32 s34, s38, 16384
  buffer_load_dwordx4 v[192:195], v8, s[24:27], s34 offen
  s_sub_u32 s93, s57, 4
  s_lshl_b32 s93, s93, 13
  s_add_u32 s93, s93, 131072
  s_cmp_lt_u32 s57, 4
  s_cselect_b32 s57, s92, s93
  v_add_u32 v254, s57, v10
  v_and_b32 v5, 15, v0
  s_add_u32 s34, s38, 24576
  buffer_load_dwordx4 v[196:199], v8, s[24:27], s34 offen
  v_lshrrev_b32 v6, 4, v0
  v_lshrrev_b32 v10, 1, v6
  v_lshlrev_b32 v10, 17, v10
  v_and_b32 v11, 1, v6
  v_lshlrev_b32 v9, 10, v11
  v_add_u32 v9, v9, v10
  s_add_u32 s34, s38, 32768
  buffer_load_dwordx4 v[200:203], v8, s[24:27], s34 offen
  v_lshlrev_b32 v7, 4, v5
  v_add_u32 v9, v9, v7
  v_lshlrev_b32 v255, 5, v11
  v_add_u32 v255, v255, v10
  v_lshlrev_b32 v7, 3, v5
  v_add_u32 v255, v255, v7
  s_add_u32 s34, s38, 40960
  buffer_load_dwordx4 v[204:207], v8, s[24:27], s34 offen
  v_add_u32 v255, 8192, v255
  s_lshl_b32 s92, s43, 11
  v_add_u32 v9, s92, v9
  s_lshl_b32 s92, s43, 6
  v_add_u32 v255, s92, v255
  s_lshl_b32 s92, s42, 2
  s_add_u32 s34, s38, 49152
  buffer_load_dwordx4 v[208:211], v8, s[24:27], s34 offen
  s_lshl_b32 s93, s55, 1
  s_add_u32 s92, s92, s93
  s_lshl_b32 s92, s92, 3
  s_add_u32 s92, s92, s21
  s_lshl_b32 s92, s92, 14
  s_add_u32 s58, s18, s92
  s_addc_u32 s59, s19, 0
  s_add_u32 s34, s38, 57344
  buffer_load_dwordx4 v[212:215], v8, s[24:27], s34 offen
  s_lshr_b32 s92, s43, 1
  s_and_b32 s93, s43, 1
  s_cmp_eq_u32 s93, 0
  s_cselect_b32 s88, -1, 0
  s_cselect_b32 s89, 0, -1
  s_cmp_eq_u32 s92, s55
  s_cselect_b32 s88, s88, 0
  s_cselect_b32 s89, s89, 0
  s_not_b64 s[90:91], s[88:89]
  s_lshl_b32 s92, s43, 3
  s_lshl_b32 s38, s23, 2
  s_add_u32 s38, s38, s51
  s_lshl_b32 s38, s38, 18
  s_add_u32 s34, s38, 0
  buffer_load_dwordx4 v[216:219], v8, s[24:27], s34 offen
  v_lshlrev_b32 v10, 2, v11
  v_add_u32 v10, s92, v10
  v_add_u32 v7, 0, v10
  v_and_b32 v11, 15, v7
  v_xor_b32 v11, v11, v5
  v_lshlrev_b32 v11, 4, v11
  s_add_u32 s34, s38, 8192
  buffer_load_dwordx4 v[220:223], v8, s[24:27], s34 offen
  v_lshlrev_b32 v7, 8, v7
  v_add_u32 v11, v11, v7
  v_add_u32 v1, 131072, v11
  v_add_u32 v7, 1, v10
  v_and_b32 v11, 15, v7
  v_xor_b32 v11, v11, v5
  s_add_u32 s34, s38, 16384
  buffer_load_dwordx4 v[224:227], v8, s[24:27], s34 offen
  v_lshlrev_b32 v11, 4, v11
  v_lshlrev_b32 v7, 8, v7
  v_add_u32 v11, v11, v7
  v_add_u32 v2, 131072, v11
  v_add_u32 v7, 2, v10
  v_and_b32 v11, 15, v7
  s_add_u32 s34, s38, 24576
  buffer_load_dwordx4 v[228:231], v8, s[24:27], s34 offen
  v_xor_b32 v11, v11, v5
  v_lshlrev_b32 v11, 4, v11
  v_lshlrev_b32 v7, 8, v7
  v_add_u32 v11, v11, v7
  v_add_u32 v3, 131072, v11
  v_add_u32 v7, 3, v10
  s_add_u32 s34, s38, 32768
  buffer_load_dwordx4 v[232:235], v8, s[24:27], s34 offen
  v_and_b32 v11, 15, v7
  v_xor_b32 v11, v11, v5
  v_lshlrev_b32 v11, 4, v11
  v_lshlrev_b32 v7, 8, v7
  v_add_u32 v11, v11, v7
  v_add_u32 v4, 131072, v11
  s_add_u32 s34, s38, 40960
  buffer_load_dwordx4 v[236:239], v8, s[24:27], s34 offen
  v_mov_b32 v6, 148992
  v_mov_b32 v7, 1
  s_add_u32 s34, s38, 49152
  buffer_load_dwordx4 v[240:243], v8, s[24:27], s34 offen
  s_add_u32 s34, s38, 57344
  buffer_load_dwordx4 v[244:247], v8, s[24:27], s34 offen
  s_waitcnt vmcnt(32)
  ds_read_b128 v[12:15], v248
  v_xor_b32 v5, 4096, v248
  ds_read_b128 v[28:31], v5
  ds_read_b128 v[16:19], v249
  v_xor_b32 v5, 4096, v249
  ds_read_b128 v[32:35], v5
  ds_read_b128 v[20:23], v250
  v_xor_b32 v5, 4096, v250
  ds_read_b128 v[36:39], v5
  ds_read_b128 v[24:27], v251
  v_xor_b32 v5, 4096, v251
  ds_read_b128 v[40:43], v5
  s_waitcnt lgkmcnt(0)
  s_mov_b32 exec_lo, 1
  s_mov_b32 exec_hi, 0
  ds_add_u32 v6, v7 offset:28
  s_mov_b64 exec, -1
  s_waitcnt vmcnt(24)
  v_perm_b32 v44, v124, v120, s40
  v_perm_b32 v45, v132, v128, s40
  v_perm_b32 v46, v140, v136, s40
  v_perm_b32 v47, v148, v144, s40
  v_perm_b32 v48, v124, v120, s41
  v_perm_b32 v49, v132, v128, s41
  v_perm_b32 v50, v140, v136, s41
  v_perm_b32 v51, v148, v144, s41
  v_mfma_f32_16x16x32_bf16 v[56:59], v[12:15], v[44:47], 0
  v_mfma_f32_16x16x32_bf16 v[88:91], v[28:31], v[44:47], 0
  v_perm_b32 v44, v125, v121, s40
  v_perm_b32 v45, v133, v129, s40
  v_perm_b32 v46, v141, v137, s40
  v_perm_b32 v47, v149, v145, s40
  v_mfma_f32_16x16x32_bf16 v[60:63], v[12:15], v[48:51], 0
  v_mfma_f32_16x16x32_bf16 v[92:95], v[28:31], v[48:51], 0
  v_perm_b32 v48, v125, v121, s41
  v_perm_b32 v49, v133, v129, s41
  v_perm_b32 v50, v141, v137, s41
  v_perm_b32 v51, v149, v145, s41
  v_mfma_f32_16x16x32_bf16 v[64:67], v[12:15], v[44:47], 0
  v_mfma_f32_16x16x32_bf16 v[96:99], v[28:31], v[44:47], 0
  v_perm_b32 v44, v126, v122, s40
  v_perm_b32 v45, v134, v130, s40
  v_perm_b32 v46, v142, v138, s40
  v_perm_b32 v47, v150, v146, s40
  v_mfma_f32_16x16x32_bf16 v[68:71], v[12:15], v[48:51], 0
  v_mfma_f32_16x16x32_bf16 v[100:103], v[28:31], v[48:51], 0
  v_perm_b32 v48, v126, v122, s41
  v_perm_b32 v49, v134, v130, s41
  v_perm_b32 v50, v142, v138, s41
  v_perm_b32 v51, v150, v146, s41
  v_mfma_f32_16x16x32_bf16 v[72:75], v[12:15], v[44:47], 0
  v_mfma_f32_16x16x32_bf16 v[104:107], v[28:31], v[44:47], 0
  v_perm_b32 v44, v127, v123, s40
  v_perm_b32 v45, v135, v131, s40
  v_perm_b32 v46, v143, v139, s40
  v_perm_b32 v47, v151, v147, s40
  v_mfma_f32_16x16x32_bf16 v[76:79], v[12:15], v[48:51], 0
  v_mfma_f32_16x16x32_bf16 v[108:111], v[28:31], v[48:51], 0
  v_perm_b32 v48, v127, v123, s41
  v_perm_b32 v49, v135, v131, s41
  v_perm_b32 v50, v143, v139, s41
  v_perm_b32 v51, v151, v147, s41
  v_mfma_f32_16x16x32_bf16 v[80:83], v[12:15], v[44:47], 0
  v_mfma_f32_16x16x32_bf16 v[112:115], v[28:31], v[44:47], 0
  v_mfma_f32_16x16x32_bf16 v[84:87], v[12:15], v[48:51], 0
  v_mfma_f32_16x16x32_bf16 v[116:119], v[28:31], v[48:51], 0
  s_waitcnt vmcnt(16)
  v_perm_b32 v44, v156, v152, s40
  v_perm_b32 v45, v164, v160, s40
  v_perm_b32 v46, v172, v168, s40
  v_perm_b32 v47, v180, v176, s40
  v_perm_b32 v48, v156, v152, s41
  v_perm_b32 v49, v164, v160, s41
  v_perm_b32 v50, v172, v168, s41
  v_perm_b32 v51, v180, v176, s41
  v_mfma_f32_16x16x32_bf16 v[56:59], v[16:19], v[44:47], v[56:59]
  v_mfma_f32_16x16x32_bf16 v[88:91], v[32:35], v[44:47], v[88:91]
  v_perm_b32 v44, v157, v153, s40
  v_perm_b32 v45, v165, v161, s40
  v_perm_b32 v46, v173, v169, s40
  v_perm_b32 v47, v181, v177, s40
  v_mfma_f32_16x16x32_bf16 v[60:63], v[16:19], v[48:51], v[60:63]
  v_mfma_f32_16x16x32_bf16 v[92:95], v[32:35], v[48:51], v[92:95]
  v_perm_b32 v48, v157, v153, s41
  v_perm_b32 v49, v165, v161, s41
  v_perm_b32 v50, v173, v169, s41
  v_perm_b32 v51, v181, v177, s41
  v_mfma_f32_16x16x32_bf16 v[64:67], v[16:19], v[44:47], v[64:67]
  v_mfma_f32_16x16x32_bf16 v[96:99], v[32:35], v[44:47], v[96:99]
  v_perm_b32 v44, v158, v154, s40
  v_perm_b32 v45, v166, v162, s40
  v_perm_b32 v46, v174, v170, s40
  v_perm_b32 v47, v182, v178, s40
  v_mfma_f32_16x16x32_bf16 v[68:71], v[16:19], v[48:51], v[68:71]
  v_mfma_f32_16x16x32_bf16 v[100:103], v[32:35], v[48:51], v[100:103]
  v_perm_b32 v48, v158, v154, s41
  v_perm_b32 v49, v166, v162, s41
  v_perm_b32 v50, v174, v170, s41
  v_perm_b32 v51, v182, v178, s41
  v_mfma_f32_16x16x32_bf16 v[72:75], v[16:19], v[44:47], v[72:75]
  v_mfma_f32_16x16x32_bf16 v[104:107], v[32:35], v[44:47], v[104:107]
  v_perm_b32 v44, v159, v155, s40
  v_perm_b32 v45, v167, v163, s40
  v_perm_b32 v46, v175, v171, s40
  v_perm_b32 v47, v183, v179, s40
  v_mfma_f32_16x16x32_bf16 v[76:79], v[16:19], v[48:51], v[76:79]
  v_mfma_f32_16x16x32_bf16 v[108:111], v[32:35], v[48:51], v[108:111]
  v_perm_b32 v48, v159, v155, s41
  v_perm_b32 v49, v167, v163, s41
  v_perm_b32 v50, v175, v171, s41
  v_perm_b32 v51, v183, v179, s41
  v_mfma_f32_16x16x32_bf16 v[80:83], v[16:19], v[44:47], v[80:83]
  v_mfma_f32_16x16x32_bf16 v[112:115], v[32:35], v[44:47], v[112:115]
  v_mfma_f32_16x16x32_bf16 v[84:87], v[16:19], v[48:51], v[84:87]
  v_mfma_f32_16x16x32_bf16 v[116:119], v[32:35], v[48:51], v[116:119]
  s_waitcnt vmcnt(8)
  v_perm_b32 v44, v188, v184, s40
  v_perm_b32 v45, v196, v192, s40
  v_perm_b32 v46, v204, v200, s40
  v_perm_b32 v47, v212, v208, s40
  v_perm_b32 v48, v188, v184, s41
  v_perm_b32 v49, v196, v192, s41
  v_perm_b32 v50, v204, v200, s41
  v_perm_b32 v51, v212, v208, s41
  v_mfma_f32_16x16x32_bf16 v[56:59], v[20:23], v[44:47], v[56:59]
  v_mfma_f32_16x16x32_bf16 v[88:91], v[36:39], v[44:47], v[88:91]
  v_perm_b32 v44, v189, v185, s40
  v_perm_b32 v45, v197, v193, s40
  v_perm_b32 v46, v205, v201, s40
  v_perm_b32 v47, v213, v209, s40
  v_mfma_f32_16x16x32_bf16 v[60:63], v[20:23], v[48:51], v[60:63]
  v_mfma_f32_16x16x32_bf16 v[92:95], v[36:39], v[48:51], v[92:95]
  v_perm_b32 v48, v189, v185, s41
  v_perm_b32 v49, v197, v193, s41
  v_perm_b32 v50, v205, v201, s41
  v_perm_b32 v51, v213, v209, s41
  v_mfma_f32_16x16x32_bf16 v[64:67], v[20:23], v[44:47], v[64:67]
  v_mfma_f32_16x16x32_bf16 v[96:99], v[36:39], v[44:47], v[96:99]
  v_perm_b32 v44, v190, v186, s40
  v_perm_b32 v45, v198, v194, s40
  v_perm_b32 v46, v206, v202, s40
  v_perm_b32 v47, v214, v210, s40
  v_mfma_f32_16x16x32_bf16 v[68:71], v[20:23], v[48:51], v[68:71]
  v_mfma_f32_16x16x32_bf16 v[100:103], v[36:39], v[48:51], v[100:103]
  v_perm_b32 v48, v190, v186, s41
  v_perm_b32 v49, v198, v194, s41
  v_perm_b32 v50, v206, v202, s41
  v_perm_b32 v51, v214, v210, s41
  v_mfma_f32_16x16x32_bf16 v[72:75], v[20:23], v[44:47], v[72:75]
  v_mfma_f32_16x16x32_bf16 v[104:107], v[36:39], v[44:47], v[104:107]
  v_perm_b32 v44, v191, v187, s40
  v_perm_b32 v45, v199, v195, s40
  v_perm_b32 v46, v207, v203, s40
  v_perm_b32 v47, v215, v211, s40
  v_mfma_f32_16x16x32_bf16 v[76:79], v[20:23], v[48:51], v[76:79]
  v_mfma_f32_16x16x32_bf16 v[108:111], v[36:39], v[48:51], v[108:111]
  v_perm_b32 v48, v191, v187, s41
  v_perm_b32 v49, v199, v195, s41
  v_perm_b32 v50, v207, v203, s41
  v_perm_b32 v51, v215, v211, s41
  v_mfma_f32_16x16x32_bf16 v[80:83], v[20:23], v[44:47], v[80:83]
  v_mfma_f32_16x16x32_bf16 v[112:115], v[36:39], v[44:47], v[112:115]
  v_mfma_f32_16x16x32_bf16 v[84:87], v[20:23], v[48:51], v[84:87]
  v_mfma_f32_16x16x32_bf16 v[116:119], v[36:39], v[48:51], v[116:119]
  s_waitcnt vmcnt(0)
L_spin_2:
  ds_read_b32 v5, v6 offset:28
  s_waitcnt lgkmcnt(0)
  v_readfirstlane_b32 s34, v5
  s_cmp_ge_u32 s34, 4
  s_cbranch_scc0 L_spin_2
  v_perm_b32 v44, v220, v216, s40
  v_perm_b32 v45, v228, v224, s40
  v_perm_b32 v46, v236, v232, s40
  v_perm_b32 v47, v244, v240, s40
  v_perm_b32 v48, v220, v216, s41
  v_perm_b32 v49, v228, v224, s41
  v_perm_b32 v50, v236, v232, s41
  v_perm_b32 v51, v244, v240, s41
  v_mfma_f32_16x16x32_bf16 v[56:59], v[24:27], v[44:47], v[56:59]
  v_mfma_f32_16x16x32_bf16 v[88:91], v[40:43], v[44:47], v[88:91]
  v_perm_b32 v44, v221, v217, s40
  v_perm_b32 v45, v229, v225, s40
  v_perm_b32 v46, v237, v233, s40
  v_perm_b32 v47, v245, v241, s40
  v_mfma_f32_16x16x32_bf16 v[60:63], v[24:27], v[48:51], v[60:63]
  v_mfma_f32_16x16x32_bf16 v[92:95], v[40:43], v[48:51], v[92:95]
  v_perm_b32 v48, v221, v217, s41
  v_perm_b32 v49, v229, v225, s41
  v_perm_b32 v50, v237, v233, s41
  v_perm_b32 v51, v245, v241, s41
  v_mfma_f32_16x16x32_bf16 v[64:67], v[24:27], v[44:47], v[64:67]
  v_mfma_f32_16x16x32_bf16 v[96:99], v[40:43], v[44:47], v[96:99]
  v_perm_b32 v44, v222, v218, s40
  v_perm_b32 v45, v230, v226, s40
  v_perm_b32 v46, v238, v234, s40
  v_perm_b32 v47, v246, v242, s40
  v_mfma_f32_16x16x32_bf16 v[68:71], v[24:27], v[48:51], v[68:71]
  v_mfma_f32_16x16x32_bf16 v[100:103], v[40:43], v[48:51], v[100:103]
  v_perm_b32 v48, v222, v218, s41
  v_perm_b32 v49, v230, v226, s41
  v_perm_b32 v50, v238, v234, s41
  v_perm_b32 v51, v246, v242, s41
  v_mfma_f32_16x16x32_bf16 v[72:75], v[24:27], v[44:47], v[72:75]
  v_mfma_f32_16x16x32_bf16 v[104:107], v[40:43], v[44:47], v[104:107]
  v_perm_b32 v44, v223, v219, s40
  v_perm_b32 v45, v231, v227, s40
  v_perm_b32 v46, v239, v235, s40
  v_perm_b32 v47, v247, v243, s40
  v_mfma_f32_16x16x32_bf16 v[76:79], v[24:27], v[48:51], v[76:79]
  v_mfma_f32_16x16x32_bf16 v[108:111], v[40:43], v[48:51], v[108:111]
  v_perm_b32 v48, v223, v219, s41
  v_perm_b32 v49, v231, v227, s41
  v_perm_b32 v50, v239, v235, s41
  v_perm_b32 v51, v247, v243, s41
  v_mfma_f32_16x16x32_bf16 v[80:83], v[24:27], v[44:47], v[80:83]
  v_mfma_f32_16x16x32_bf16 v[112:115], v[40:43], v[44:47], v[112:115]
  v_mfma_f32_16x16x32_bf16 v[84:87], v[24:27], v[48:51], v[84:87]
  v_mfma_f32_16x16x32_bf16 v[116:119], v[40:43], v[48:51], v[116:119]
  s_cmp_lt_u32 s23, 2
  s_cbranch_scc1 L_owner_3
  s_nop 5
  ds_write_b128 v53, v[56:59] offset:0
  ds_write_b128 v53, v[60:63] offset:1024
  ds_write_b128 v53, v[64:67] offset:2048
  ds_write_b128 v53, v[68:71] offset:3072
  ds_write_b128 v53, v[72:75] offset:4096
  ds_write_b128 v53, v[76:79] offset:5120
  ds_write_b128 v53, v[80:83] offset:6144
  ds_write_b128 v53, v[84:87] offset:7168
L_owner_3:
  s_nop 5
  ds_write_b128 v52, v[88:91] offset:0
  ds_write_b128 v52, v[92:95] offset:1024
  ds_write_b128 v52, v[96:99] offset:2048
  ds_write_b128 v52, v[100:103] offset:3072
  ds_write_b128 v52, v[104:107] offset:4096
  ds_write_b128 v52, v[108:111] offset:5120
  ds_write_b128 v52, v[112:115] offset:6144
  ds_write_b128 v52, v[116:119] offset:7168
  s_waitcnt lgkmcnt(0)
  s_mov_b32 exec_lo, 1
  s_mov_b32 exec_hi, 0
  ds_add_u32 v6, v7 offset:0
  s_mov_b64 exec, -1
  s_cmp_ge_u32 s23, 2
  s_cbranch_scc1 L_qwait_4
L_spin_5:
  ds_read_b32 v5, v6 offset:0
  s_waitcnt lgkmcnt(0)
  v_readfirstlane_b32 s34, v5
  s_cmp_ge_u32 s34, 4
  s_cbranch_scc0 L_spin_5
  ds_read_b128 v[120:123], v54 offset:0
  ds_read_b128 v[124:127], v54 offset:1024
  ds_read_b128 v[128:131], v54 offset:2048
  ds_read_b128 v[132:135], v54 offset:3072
  ds_read_b128 v[136:139], v54 offset:4096
  ds_read_b128 v[140:143], v54 offset:5120
  ds_read_b128 v[144:147], v54 offset:6144
  ds_read_b128 v[148:151], v54 offset:7168
  ds_read_b128 v[152:155], v55 offset:0
  ds_read_b128 v[156:159], v55 offset:1024
  ds_read_b128 v[160:163], v55 offset:2048
  ds_read_b128 v[164:167], v55 offset:3072
  ds_read_b128 v[168:171], v55 offset:4096
  ds_read_b128 v[172:175], v55 offset:5120
  ds_read_b128 v[176:179], v55 offset:6144
  ds_read_b128 v[180:183], v55 offset:7168
  ds_read_b128 v[184:187], v254 offset:0
  ds_read_b128 v[188:191], v254 offset:1024
  ds_read_b128 v[192:195], v254 offset:2048
  ds_read_b128 v[196:199], v254 offset:3072
  ds_read_b128 v[200:203], v254 offset:4096
  ds_read_b128 v[204:207], v254 offset:5120
  ds_read_b128 v[208:211], v254 offset:6144
  ds_read_b128 v[212:215], v254 offset:7168
  s_waitcnt lgkmcnt(15)
  v_pk_add_f32 v[56:57], v[56:57], v[120:121]
  v_pk_add_f32 v[58:59], v[58:59], v[122:123]
  v_pk_add_f32 v[60:61], v[60:61], v[124:125]
  v_pk_add_f32 v[62:63], v[62:63], v[126:127]
  v_pk_add_f32 v[64:65], v[64:65], v[128:129]
  v_pk_add_f32 v[66:67], v[66:67], v[130:131]
  v_pk_add_f32 v[68:69], v[68:69], v[132:133]
  v_pk_add_f32 v[70:71], v[70:71], v[134:135]
  s_waitcnt lgkmcnt(15)
  v_pk_add_f32 v[72:73], v[72:73], v[136:137]
  v_pk_add_f32 v[74:75], v[74:75], v[138:139]
  v_pk_add_f32 v[76:77], v[76:77], v[140:141]
  v_pk_add_f32 v[78:79], v[78:79], v[142:143]
  v_pk_add_f32 v[80:81], v[80:81], v[144:145]
  v_pk_add_f32 v[82:83], v[82:83], v[146:147]
  v_pk_add_f32 v[84:85], v[84:85], v[148:149]
  v_pk_add_f32 v[86:87], v[86:87], v[150:151]
  s_waitcnt lgkmcnt(12)
  v_pk_add_f32 v[56:57], v[56:57], v[152:153]
  v_pk_add_f32 v[58:59], v[58:59], v[154:155]
  v_pk_add_f32 v[60:61], v[60:61], v[156:157]
  v_pk_add_f32 v[62:63], v[62:63], v[158:159]
  v_pk_add_f32 v[64:65], v[64:65], v[160:161]
  v_pk_add_f32 v[66:67], v[66:67], v[162:163]
  v_pk_add_f32 v[68:69], v[68:69], v[164:165]
  v_pk_add_f32 v[70:71], v[70:71], v[166:167]
  s_waitcnt lgkmcnt(8)
  v_pk_add_f32 v[72:73], v[72:73], v[168:169]
  v_pk_add_f32 v[74:75], v[74:75], v[170:171]
  v_pk_add_f32 v[76:77], v[76:77], v[172:173]
  v_pk_add_f32 v[78:79], v[78:79], v[174:175]
  v_pk_add_f32 v[80:81], v[80:81], v[176:177]
  v_pk_add_f32 v[82:83], v[82:83], v[178:179]
  v_pk_add_f32 v[84:85], v[84:85], v[180:181]
  v_pk_add_f32 v[86:87], v[86:87], v[182:183]
  s_waitcnt lgkmcnt(4)
  v_pk_add_f32 v[56:57], v[56:57], v[184:185]
  v_pk_add_f32 v[58:59], v[58:59], v[186:187]
  v_pk_add_f32 v[60:61], v[60:61], v[188:189]
  v_pk_add_f32 v[62:63], v[62:63], v[190:191]
  v_pk_add_f32 v[64:65], v[64:65], v[192:193]
  v_pk_add_f32 v[66:67], v[66:67], v[194:195]
  v_pk_add_f32 v[68:69], v[68:69], v[196:197]
  v_pk_add_f32 v[70:71], v[70:71], v[198:199]
  s_waitcnt lgkmcnt(0)
  s_mov_b32 exec_lo, 1
  s_mov_b32 exec_hi, 0
  ds_add_u32 v6, v7 offset:4
  s_mov_b64 exec, -1
  v_pk_add_f32 v[72:73], v[72:73], v[200:201]
  v_pk_add_f32 v[74:75], v[74:75], v[202:203]
  v_pk_add_f32 v[76:77], v[76:77], v[204:205]
  v_pk_add_f32 v[78:79], v[78:79], v[206:207]
  v_pk_add_f32 v[80:81], v[80:81], v[208:209]
  v_pk_add_f32 v[82:83], v[82:83], v[210:211]
  v_pk_add_f32 v[84:85], v[84:85], v[212:213]
  v_pk_add_f32 v[86:87], v[86:87], v[214:215]
  v_cvt_pk_bf16_f32 v120, v56, v60
  v_cvt_pk_bf16_f32 v121, v64, v68
  v_cvt_pk_bf16_f32 v122, v72, v76
  v_cvt_pk_bf16_f32 v123, v80, v84
  v_cvt_pk_bf16_f32 v124, v57, v61
  v_cvt_pk_bf16_f32 v125, v65, v69
  v_cvt_pk_bf16_f32 v126, v73, v77
  v_cvt_pk_bf16_f32 v127, v81, v85
  v_cvt_pk_bf16_f32 v128, v58, v62
  v_cvt_pk_bf16_f32 v129, v66, v70
  v_cvt_pk_bf16_f32 v130, v74, v78
  v_cvt_pk_bf16_f32 v131, v82, v86
  v_cvt_pk_bf16_f32 v132, v59, v63
  v_cvt_pk_bf16_f32 v133, v67, v71
  v_cvt_pk_bf16_f32 v134, v75, v79
  v_cvt_pk_bf16_f32 v135, v83, v87
  s_mov_b64 exec, s[90:91]
  global_store_dwordx4 v9, v[120:123], s[58:59] offset:0 sc1
  global_store_dwordx4 v9, v[124:127], s[58:59] offset:256 sc1
  global_store_dwordx4 v9, v[128:131], s[58:59] offset:512 sc1
  global_store_dwordx4 v9, v[132:135], s[58:59] offset:768 sc1
  s_mov_b64 exec, -1
  v_xor_b32 v136, v120, v121
  v_xor_b32 v140, v122, v123
  v_xor_b32 v137, v124, v125
  v_xor_b32 v141, v126, v127
  v_xor_b32 v138, v128, v129
  v_xor_b32 v142, v130, v131
  v_xor_b32 v139, v132, v133
  v_xor_b32 v143, v134, v135
  v_xor_b32 v136, v136, v140
  v_xor_b32 v137, v137, v141
  v_xor_b32 v138, v138, v142
  v_xor_b32 v139, v139, v143
  v_xor_b32_dpp v136, v136, v136 row_ror:8 row_mask:0xf bank_mask:0xf
  v_xor_b32_dpp v137, v137, v137 row_ror:8 row_mask:0xf bank_mask:0xf
  v_xor_b32_dpp v138, v138, v138 row_ror:8 row_mask:0xf bank_mask:0xf
  v_xor_b32_dpp v139, v139, v139 row_ror:8 row_mask:0xf bank_mask:0xf
  v_xor_b32_dpp v136, v136, v136 row_ror:4 row_mask:0xf bank_mask:0xf
  v_xor_b32_dpp v137, v137, v137 row_ror:4 row_mask:0xf bank_mask:0xf
  v_xor_b32_dpp v138, v138, v138 row_ror:4 row_mask:0xf bank_mask:0xf
  v_xor_b32_dpp v139, v139, v139 row_ror:4 row_mask:0xf bank_mask:0xf
  v_xor_b32_dpp v136, v136, v136 row_ror:2 row_mask:0xf bank_mask:0xf
  v_xor_b32_dpp v137, v137, v137 row_ror:2 row_mask:0xf bank_mask:0xf
  v_xor_b32_dpp v138, v138, v138 row_ror:2 row_mask:0xf bank_mask:0xf
  v_xor_b32_dpp v139, v139, v139 row_ror:2 row_mask:0xf bank_mask:0xf
  v_xor_b32_dpp v136, v136, v136 row_ror:1 row_mask:0xf bank_mask:0xf
  v_xor_b32_dpp v137, v137, v137 row_ror:1 row_mask:0xf bank_mask:0xf
  v_xor_b32_dpp v138, v138, v138 row_ror:1 row_mask:0xf bank_mask:0xf
  v_xor_b32_dpp v139, v139, v139 row_ror:1 row_mask:0xf bank_mask:0xf
  s_mov_b32 s56, 0x20002
  s_mov_b32 s57, 0x20002
  v_cndmask_b32 v136, v136, v137, s[56:57]
  s_mov_b32 s56, 0x40004
  s_mov_b32 s57, 0x40004
  v_cndmask_b32 v136, v136, v138, s[56:57]
  s_mov_b32 s56, 0x80008
  s_mov_b32 s57, 0x80008
  v_cndmask_b32 v136, v136, v139, s[56:57]
  v_mov_b32 v144, s62
  v_xor_b32 v145, s61, v136
  s_mov_b32 s56, 0x000f000f
  s_mov_b32 s57, 0x000f000f
  s_and_b64 exec, s[56:57], s[90:91]
  global_store_dwordx2 v255, v[144:145], s[58:59] sc1
  s_mov_b64 exec, -1
  s_cmp_eq_u64 s[88:89], 0
  s_cbranch_scc1 L_nolocal_6
L_spin_7:
  ds_read_b32 v5, v6 offset:4
  s_waitcnt lgkmcnt(0)
  v_readfirstlane_b32 s34, v5
  s_cmp_ge_u32 s34, 2
  s_cbranch_scc0 L_spin_7
  s_mov_b64 exec, s[88:89]
  ds_write_b128 v1, v[120:123]
  ds_write_b128 v2, v[124:127]
  ds_write_b128 v3, v[128:131]
  ds_write_b128 v4, v[132:135]
  s_mov_b64 exec, -1
L_nolocal_6:
  s_waitcnt vmcnt(0)
  v_mov_b32 v6, 148992
  v_mov_b32 v7, 1
  s_mov_b32 exec_lo, 1
  s_mov_b32 exec_hi, 0
  ds_add_u32 v6, v7 offset:8
  s_mov_b64 exec, -1
L_qwait_4:
  s_cmp_eq_u32 s23, s43
  s_cbranch_scc1 L_qskip_10
  s_lshl_b32 s34, s2, 14
  s_add_u32 s58, s18, s34
  s_addc_u32 s59, s19, 0
  s_lshl_b32 s34, s23, 11
  v_lshlrev_b32 v1, 4, v0
  v_add_u32 v1, s34, v1
  v_lshrrev_b32 v2, 4, v0
  v_and_b32 v3, 15, v0
  s_lshl_b32 s34, s23, 3
  v_add_u32 v2, s34, v2
  v_lshlrev_b32 v4, 3, v2
  v_add_u32 v4, 8192, v4
  v_add_u32 v5, 0, v2
  v_and_b32 v6, 15, v5
  v_xor_b32 v6, v6, v3
  v_lshlrev_b32 v6, 4, v6
  v_lshlrev_b32 v5, 8, v5
  v_add_u32 v5, v5, v6
  v_add_u32 v32, 131072, v5
  v_add_u32 v5, 4, v2
  v_and_b32 v6, 15, v5
  v_xor_b32 v6, v6, v3
  v_lshlrev_b32 v6, 4, v6
  v_lshlrev_b32 v5, 8, v5
  v_add_u32 v5, v5, v6
  v_add_u32 v33, 131072, v5
  v_mov_b32 v6, 148992
L_spin_11:
  ds_read_b32 v5, v6 offset:8
  s_waitcnt lgkmcnt(0)
  v_readfirstlane_b32 s34, v5
  s_cmp_ge_u32 s34, 2
  s_cbranch_scc0 L_spin_11
  s_mov_b32 s57, 200000
L_qpoll_8:
  global_load_dwordx4 v[12:15], v1, s[58:59] offset:0 sc1
  global_load_dwordx4 v[16:19], v1, s[58:59] offset:1024 sc1
  global_load_dwordx2 v[20:21], v4, s[58:59] offset:0 sc1
  global_load_dwordx2 v[22:23], v4, s[58:59] offset:32 sc1
  s_waitcnt vmcnt(0)
  v_xor_b32 v24, v12, v13
  v_xor_b32 v26, v14, v15
  v_xor_b32 v25, v16, v17
  v_xor_b32 v27, v18, v19
  v_xor_b32 v24, v24, v26
  v_xor_b32 v25, v25, v27
  v_subrev_u32 v26, s60, v20
  v_lshrrev_b32 v26, 12, v26
  v_subrev_u32 v27, s60, v22
  v_lshrrev_b32 v27, 12, v27
  v_xor_b32_dpp v24, v24, v24 row_ror:8 row_mask:0xf bank_mask:0xf
  v_xor_b32_dpp v25, v25, v25 row_ror:8 row_mask:0xf bank_mask:0xf
  s_nop 0
  v_xor_b32_dpp v24, v24, v24 row_ror:4 row_mask:0xf bank_mask:0xf
  v_xor_b32_dpp v25, v25, v25 row_ror:4 row_mask:0xf bank_mask:0xf
  s_nop 0
  v_xor_b32_dpp v24, v24, v24 row_ror:2 row_mask:0xf bank_mask:0xf
  v_xor_b32_dpp v25, v25, v25 row_ror:2 row_mask:0xf bank_mask:0xf
  s_nop 0
  v_xor_b32_dpp v24, v24, v24 row_ror:1 row_mask:0xf bank_mask:0xf
  v_xor_b32_dpp v25, v25, v25 row_ror:1 row_mask:0xf bank_mask:0xf
  s_nop 0
  v_xor_b32 v24, v24, v20
  v_xor_b32 v24, v24, v21
  v_xor_b32 v24, 0x9e3779b9, v24
  v_xor_b32 v25, v25, v22
  v_xor_b32 v25, v25, v23
  v_xor_b32 v25, 0x9e3779b9, v25
  v_or3_b32 v28, v24, v25, v26
  v_or_b32 v28, v28, v27
  v_cmp_ne_u32 vcc, 0, v28
  s_cbranch_vccz L_qdone_9
  s_sub_u32 s57, s57, 1
  s_cmp_eq_u32 s57, 0
  s_cbranch_scc1 L_qdone_9
  s_sleep 4
  s_branch L_qpoll_8
L_qdone_9:
  ds_write_b128 v32, v[12:15]
  ds_write_b128 v33, v[16:19]
L_qskip_10:
  s_waitcnt lgkmcnt(0)
  s_setprio 0
  s_barrier
  v_mov_b32 v6, 148992
L_plwait_12:
  s_sleep 2
  ds_read_b32 v5, v6 offset:20
  s_waitcnt lgkmcnt(0)
  v_readfirstlane_b32 s34, v5
  s_cmp_ge_u32 s34, 1
  s_cbranch_scc0 L_plwait_12
  s_lshl_b32 s34, s21, 19
  s_add_u32 s48, s12, s34
  s_addc_u32 s49, s13, 0
  s_and_b32 s49, s49, 0xffff
  s_mov_b32 s50, 524288
  s_mov_b32 s51, 0x20000
  s_lshl_b32 s38, s22, 4
  s_lshl_b32 s52, s23, 2
  s_add_u32 s38, s38, s52
  s_lshl_b32 s38, s38, 10
  v_lshlrev_b32 v1, 4, v0
  buffer_load_dwordx4 v[12:15], v1, s[48:51], s38 offen offset:0
  buffer_load_dwordx4 v[16:19], v1, s[48:51], s38 offen offset:1024
  buffer_load_dwordx4 v[20:23], v1, s[48:51], s38 offen offset:2048
  buffer_load_dwordx4 v[24:27], v1, s[48:51], s38 offen offset:3072
  s_waitcnt vmcnt(0)
  s_mov_b32 s34, 0
  buffer_load_dwordx4 v[12:15], v252, s[44:47], s34 offen offset:0
  s_mov_b32 s34, 0
  buffer_load_dwordx4 v[16:19], v252, s[44:47], s34 offen offset:1024
  s_mov_b32 s34, 0
  buffer_load_dwordx4 v[20:23], v252, s[44:47], s34 offen offset:2048
  s_mov_b32 s34, 0
  buffer_load_dwordx4 v[24:27], v252, s[44:47], s34 offen offset:3072
  s_waitcnt vmcnt(0)
  s_mov_b32 s34, 4096
  buffer_load_dwordx4 v[28:31], v252, s[44:47], s34 offen offset:0
  s_mov_b32 s34, 4096
  buffer_load_dwordx4 v[32:35], v252, s[44:47], s34 offen offset:1024
  s_mov_b32 s34, 4096
  buffer_load_dwordx4 v[36:39], v252, s[44:47], s34 offen offset:2048
  s_mov_b32 s34, 4096
  buffer_load_dwordx4 v[40:43], v252, s[44:47], s34 offen offset:3072
  s_waitcnt vmcnt(0)
  s_waitcnt vmcnt(0)
  v_perm_b32 v56, v16, v12, s40
  v_perm_b32 v57, v24, v20, s40
  v_perm_b32 v58, v32, v28, s40
  v_perm_b32 v59, v40, v36, s40
  v_perm_b32 v64, v16, v12, s41
  v_perm_b32 v65, v24, v20, s41
  v_perm_b32 v66, v32, v28, s41
  v_perm_b32 v67, v40, v36, s41
  v_perm_b32 v72, v17, v13, s40
  v_perm_b32 v73, v25, v21, s40
  v_perm_b32 v74, v33, v29, s40
  v_perm_b32 v75, v41, v37, s40
  v_perm_b32 v80, v17, v13, s41
  v_perm_b32 v81, v25, v21, s41
  v_perm_b32 v82, v33, v29, s41
  v_perm_b32 v83, v41, v37, s41
  v_perm_b32 v88, v18, v14, s40
  v_perm_b32 v89, v26, v22, s40
  v_perm_b32 v90, v34, v30, s40
  v_perm_b32 v91, v42, v38, s40
  v_perm_b32 v96, v18, v14, s41
  v_perm_b32 v97, v26, v22, s41
  v_perm_b32 v98, v34, v30, s41
  v_perm_b32 v99, v42, v38, s41
  v_perm_b32 v104, v19, v15, s40
  v_perm_b32 v105, v27, v23, s40
  v_perm_b32 v106, v35, v31, s40
  v_perm_b32 v107, v43, v39, s40
  v_perm_b32 v112, v19, v15, s41
  v_perm_b32 v113, v27, v23, s41
  v_perm_b32 v114, v35, v31, s41
  v_perm_b32 v115, v43, v39, s41
  s_mov_b32 s34, 32768
  buffer_load_dwordx4 v[12:15], v252, s[44:47], s34 offen offset:0
  s_mov_b32 s34, 32768
  buffer_load_dwordx4 v[16:19], v252, s[44:47], s34 offen offset:1024
  s_mov_b32 s34, 32768
  buffer_load_dwordx4 v[20:23], v252, s[44:47], s34 offen offset:2048
  s_mov_b32 s34, 32768
  buffer_load_dwordx4 v[24:27], v252, s[44:47], s34 offen offset:3072
  s_waitcnt vmcnt(0)
  s_mov_b32 s34, 36864
  buffer_load_dwordx4 v[28:31], v252, s[44:47], s34 offen offset:0
  s_mov_b32 s34, 36864
  buffer_load_dwordx4 v[32:35], v252, s[44:47], s34 offen offset:1024
  s_mov_b32 s34, 36864
  buffer_load_dwordx4 v[36:39], v252, s[44:47], s34 offen offset:2048
  s_mov_b32 s34, 36864
  buffer_load_dwordx4 v[40:43], v252, s[44:47], s34 offen offset:3072
  s_waitcnt vmcnt(0)
  s_waitcnt vmcnt(0)
  v_perm_b32 v60, v16, v12, s40
  v_perm_b32 v61, v24, v20, s40
  v_perm_b32 v62, v32, v28, s40
  v_perm_b32 v63, v40, v36, s40
  v_perm_b32 v68, v16, v12, s41
  v_perm_b32 v69, v24, v20, s41
  v_perm_b32 v70, v32, v28, s41
  v_perm_b32 v71, v40, v36, s41
  v_perm_b32 v76, v17, v13, s40
  v_perm_b32 v77, v25, v21, s40
  v_perm_b32 v78, v33, v29, s40
  v_perm_b32 v79, v41, v37, s40
  v_perm_b32 v84, v17, v13, s41
  v_perm_b32 v85, v25, v21, s41
  v_perm_b32 v86, v33, v29, s41
  v_perm_b32 v87, v41, v37, s41
  v_perm_b32 v92, v18, v14, s40
  v_perm_b32 v93, v26, v22, s40
  v_perm_b32 v94, v34, v30, s40
  v_perm_b32 v95, v42, v38, s40
  v_perm_b32 v100, v18, v14, s41
  v_perm_b32 v101, v26, v22, s41
  v_perm_b32 v102, v34, v30, s41
  v_perm_b32 v103, v42, v38, s41
  v_perm_b32 v108, v19, v15, s40
  v_perm_b32 v109, v27, v23, s40
  v_perm_b32 v110, v35, v31, s40
  v_perm_b32 v111, v43, v39, s40
  v_perm_b32 v116, v19, v15, s41
  v_perm_b32 v117, v27, v23, s41
  v_perm_b32 v118, v35, v31, s41
  v_perm_b32 v119, v43, v39, s41
  s_mov_b32 s34, 65536
  buffer_load_dwordx4 v[12:15], v252, s[44:47], s34 offen offset:0
  s_mov_b32 s34, 65536
  buffer_load_dwordx4 v[16:19], v252, s[44:47], s34 offen offset:1024
  s_mov_b32 s34, 65536
  buffer_load_dwordx4 v[20:23], v252, s[44:47], s34 offen offset:2048
  s_mov_b32 s34, 65536
  buffer_load_dwordx4 v[24:27], v252, s[44:47], s34 offen offset:3072
  s_waitcnt vmcnt(0)
  s_mov_b32 s34, 69632
  buffer_load_dwordx4 v[28:31], v252, s[44:47], s34 offen offset:0
  s_mov_b32 s34, 69632
  buffer_load_dwordx4 v[32:35], v252, s[44:47], s34 offen offset:1024
  s_mov_b32 s34, 69632
  buffer_load_dwordx4 v[36:39], v252, s[44:47], s34 offen offset:2048
  s_mov_b32 s34, 69632
  buffer_load_dwordx4 v[40:43], v252, s[44:47], s34 offen offset:3072
  s_waitcnt vmcnt(0)
  s_waitcnt vmcnt(0)
  v_perm_b32 v120, v16, v12, s40
  v_perm_b32 v121, v24, v20, s40
  v_perm_b32 v122, v32, v28, s40
  v_perm_b32 v123, v40, v36, s40
  v_perm_b32 v128, v16, v12, s41
  v_perm_b32 v129, v24, v20, s41
  v_perm_b32 v130, v32, v28, s41
  v_perm_b32 v131, v40, v36, s41
  v_perm_b32 v136, v17, v13, s40
  v_perm_b32 v137, v25, v21, s40
  v_perm_b32 v138, v33, v29, s40
  v_perm_b32 v139, v41, v37, s40
  v_perm_b32 v144, v17, v13, s41
  v_perm_b32 v145, v25, v21, s41
  v_perm_b32 v146, v33, v29, s41
  v_perm_b32 v147, v41, v37, s41
  v_perm_b32 v152, v18, v14, s40
  v_perm_b32 v153, v26, v22, s40
  v_perm_b32 v154, v34, v30, s40
  v_perm_b32 v155, v42, v38, s40
  v_perm_b32 v160, v18, v14, s41
  v_perm_b32 v161, v26, v22, s41
  v_perm_b32 v162, v34, v30, s41
  v_perm_b32 v163, v42, v38, s41
  v_perm_b32 v168, v19, v15, s40
  v_perm_b32 v169, v27, v23, s40
  v_perm_b32 v170, v35, v31, s40
  v_perm_b32 v171, v43, v39, s40
  v_perm_b32 v176, v19, v15, s41
  v_perm_b32 v177, v27, v23, s41
  v_perm_b32 v178, v35, v31, s41
  v_perm_b32 v179, v43, v39, s41
  s_mov_b32 s34, 98304
  buffer_load_dwordx4 v[12:15], v252, s[44:47], s34 offen offset:0
  s_mov_b32 s34, 98304
  buffer_load_dwordx4 v[16:19], v252, s[44:47], s34 offen offset:1024
  s_mov_b32 s34, 98304
  buffer_load_dwordx4 v[20:23], v252, s[44:47], s34 offen offset:2048
  s_mov_b32 s34, 98304
  buffer_load_dwordx4 v[24:27], v252, s[44:47], s34 offen offset:3072
  s_waitcnt vmcnt(0)
  s_mov_b32 s34, 102400
  buffer_load_dwordx4 v[28:31], v252, s[44:47], s34 offen offset:0
  s_mov_b32 s34, 102400
  buffer_load_dwordx4 v[32:35], v252, s[44:47], s34 offen offset:1024
  s_mov_b32 s34, 102400
  buffer_load_dwordx4 v[36:39], v252, s[44:47], s34 offen offset:2048
  s_mov_b32 s34, 102400
  buffer_load_dwordx4 v[40:43], v252, s[44:47], s34 offen offset:3072
  s_waitcnt vmcnt(0)
  s_waitcnt vmcnt(0)
  v_perm_b32 v124, v16, v12, s40
  v_perm_b32 v125, v24, v20, s40
  v_perm_b32 v126, v32, v28, s40
  v_perm_b32 v127, v40, v36, s40
  v_perm_b32 v132, v16, v12, s41
  v_perm_b32 v133, v24, v20, s41
  v_perm_b32 v134, v32, v28, s41
  v_perm_b32 v135, v40, v36, s41
  v_perm_b32 v140, v17, v13, s40
  v_perm_b32 v141, v25, v21, s40
  v_perm_b32 v142, v33, v29, s40
  v_perm_b32 v143, v41, v37, s40
  v_perm_b32 v148, v17, v13, s41
  v_perm_b32 v149, v25, v21, s41
  v_perm_b32 v150, v33, v29, s41
  v_perm_b32 v151, v41, v37, s41
  v_perm_b32 v156, v18, v14, s40
  v_perm_b32 v157, v26, v22, s40
  v_perm_b32 v158, v34, v30, s40
  v_perm_b32 v159, v42, v38, s40
  v_perm_b32 v164, v18, v14, s41
  v_perm_b32 v165, v26, v22, s41
  v_perm_b32 v166, v34, v30, s41
  v_perm_b32 v167, v42, v38, s41
  v_perm_b32 v172, v19, v15, s40
  v_perm_b32 v173, v27, v23, s40
  v_perm_b32 v174, v35, v31, s40
  v_perm_b32 v175, v43, v39, s40
  v_perm_b32 v180, v19, v15, s41
  v_perm_b32 v181, v27, v23, s41
  v_perm_b32 v182, v35, v31, s41
  v_perm_b32 v183, v43, v39, s41
  s_mov_b32 s34, 131072
  buffer_load_dwordx4 v[12:15], v252, s[44:47], s34 offen offset:0
  s_mov_b32 s34, 131072
  buffer_load_dwordx4 v[16:19], v252, s[44:47], s34 offen offset:1024
  s_mov_b32 s34, 131072
  buffer_load_dwordx4 v[20:23], v252, s[44:47], s34 offen offset:2048
  s_mov_b32 s34, 131072
  buffer_load_dwordx4 v[24:27], v252, s[44:47], s34 offen offset:3072
  s_waitcnt vmcnt(0)
  s_mov_b32 s34, 135168
  buffer_load_dwordx4 v[28:31], v252, s[44:47], s34 offen offset:0
  s_mov_b32 s34, 135168
  buffer_load_dwordx4 v[32:35], v252, s[44:47], s34 offen offset:1024
  s_mov_b32 s34, 135168
  buffer_load_dwordx4 v[36:39], v252, s[44:47], s34 offen offset:2048
  s_mov_b32 s34, 135168
  buffer_load_dwordx4 v[40:43], v252, s[44:47], s34 offen offset:3072
  s_waitcnt vmcnt(0)
  s_waitcnt vmcnt(0)
  v_perm_b32 v184, v16, v12, s40
  v_perm_b32 v185, v24, v20, s40
  v_perm_b32 v186, v32, v28, s40
  v_perm_b32 v187, v40, v36, s40
  v_perm_b32 v192, v16, v12, s41
  v_perm_b32 v193, v24, v20, s41
  v_perm_b32 v194, v32, v28, s41
  v_perm_b32 v195, v40, v36, s41
  v_perm_b32 v200, v17, v13, s40
  v_perm_b32 v201, v25, v21, s40
  v_perm_b32 v202, v33, v29, s40
  v_perm_b32 v203, v41, v37, s40
  v_perm_b32 v208, v17, v13, s41
  v_perm_b32 v209, v25, v21, s41
  v_perm_b32 v210, v33, v29, s41
  v_perm_b32 v211, v41, v37, s41
  v_perm_b32 v216, v18, v14, s40
  v_perm_b32 v217, v26, v22, s40
  v_perm_b32 v218, v34, v30, s40
  v_perm_b32 v219, v42, v38, s40
  v_perm_b32 v224, v18, v14, s41
  v_perm_b32 v225, v26, v22, s41
  v_perm_b32 v226, v34, v30, s41
  v_perm_b32 v227, v42, v38, s41
  v_perm_b32 v232, v19, v15, s40
  v_perm_b32 v233, v27, v23, s40
  v_perm_b32 v234, v35, v31, s40
  v_perm_b32 v235, v43, v39, s40
  v_perm_b32 v240, v19, v15, s41
  v_perm_b32 v241, v27, v23, s41
  v_perm_b32 v242, v35, v31, s41
  v_perm_b32 v243, v43, v39, s41
  s_mov_b32 s34, 163840
  buffer_load_dwordx4 v[12:15], v252, s[44:47], s34 offen offset:0
  s_mov_b32 s34, 163840
  buffer_load_dwordx4 v[16:19], v252, s[44:47], s34 offen offset:1024
  s_mov_b32 s34, 163840
  buffer_load_dwordx4 v[20:23], v252, s[44:47], s34 offen offset:2048
  s_mov_b32 s34, 163840
  buffer_load_dwordx4 v[24:27], v252, s[44:47], s34 offen offset:3072
  s_waitcnt vmcnt(0)
  s_mov_b32 s34, 167936
  buffer_load_dwordx4 v[28:31], v252, s[44:47], s34 offen offset:0
  s_mov_b32 s34, 167936
  buffer_load_dwordx4 v[32:35], v252, s[44:47], s34 offen offset:1024
  s_mov_b32 s34, 167936
  buffer_load_dwordx4 v[36:39], v252, s[44:47], s34 offen offset:2048
  s_mov_b32 s34, 167936
  buffer_load_dwordx4 v[40:43], v252, s[44:47], s34 offen offset:3072
  s_waitcnt vmcnt(0)
  s_waitcnt vmcnt(0)
  v_perm_b32 v188, v16, v12, s40
  v_perm_b32 v189, v24, v20, s40
  v_perm_b32 v190, v32, v28, s40
  v_perm_b32 v191, v40, v36, s40
  v_perm_b32 v196, v16, v12, s41
  v_perm_b32 v197, v24, v20, s41
  v_perm_b32 v198, v32, v28, s41
  v_perm_b32 v199, v40, v36, s41
  v_perm_b32 v204, v17, v13, s40
  v_perm_b32 v205, v25, v21, s40
  v_perm_b32 v206, v33, v29, s40
  v_perm_b32 v207, v41, v37, s40
  v_perm_b32 v212, v17, v13, s41
  v_perm_b32 v213, v25, v21, s41
  v_perm_b32 v214, v33, v29, s41
  v_perm_b32 v215, v41, v37, s41
  v_perm_b32 v220, v18, v14, s40
  v_perm_b32 v221, v26, v22, s40
  v_perm_b32 v222, v34, v30, s40
  v_perm_b32 v223, v42, v38, s40
  v_perm_b32 v228, v18, v14, s41
  v_perm_b32 v229, v26, v22, s41
  v_perm_b32 v230, v34, v30, s41
  v_perm_b32 v231, v42, v38, s41
  v_perm_b32 v236, v19, v15, s40
  v_perm_b32 v237, v27, v23, s40
  v_perm_b32 v238, v35, v31, s40
  v_perm_b32 v239, v43, v39, s40
  v_perm_b32 v244, v19, v15, s41
  v_perm_b32 v245, v27, v23, s41
  v_perm_b32 v246, v35, v31, s41
  v_perm_b32 v247, v43, v39, s41
  v_and_b32 v1, 8, v0
  v_mov_b32 v2, 0x4444
  v_mov_b32 v3, 0xeeee
  v_cmp_ne_u32 vcc, 0, v1
  s_nop 1
  v_cndmask_b32 v255, v2, v3, vcc
  s_lshl_b32 s34, s20, 6
  v_add_u32 v1, s34, v0
  v_lshrrev_b32 v2, 4, v1
  v_and_b32 v3, 15, v1
  v_lshlrev_b32 v52, 5, v2
  v_add_u32 v52, 147968, v52
  v_and_b32 v5, 7, v2
  v_xor_b32 v5, v5, v3
  v_lshlrev_b32 v5, 4, v5
  v_lshlrev_b32 v6, 9, v2
  v_add_u32 v5, v5, v6
  v_add_u32 v53, 16384, v5
  v_add_u32 v54, 65536, v53
  v_and_b32 v4, 7, v2
  v_mul_u32_u24 v4, 544, v4
  v_lshrrev_b32 v5, 3, v2
  v_lshlrev_b32 v5, 7, v5
  v_add_u32 v4, v4, v5
  v_lshlrev_b32 v5, 2, v3
  v_add_u32 v4, v4, v5
  v_add_u32 v55, 139264, v4
  s_mov_b32 s36, 0x3e0293ee
  s_barrier
  ds_read_b128 v[8:11], v52
  ds_read_b128 v[12:15], v52 offset:16
  ds_read_b128 v[16:19], v53 offset:0
  ds_read_b128 v[20:23], v53 offset:256
  ds_read_b128 v[24:27], v53 offset:32768
  ds_read_b128 v[28:31], v53 offset:33024
  ds_read_b128 v[32:35], v54 offset:0
  ds_read_b128 v[36:39], v54 offset:256
  ds_read_b128 v[40:43], v54 offset:32768
  ds_read_b128 v[44:47], v54 offset:33024
  s_waitcnt lgkmcnt(8)
  v_max3_f32 v48, v8, v9, v10
  v_max_f32 v48, v48, v11
  v_sub_f32 v8, v8, v48
  v_sub_f32 v9, v9, v48
  v_sub_f32 v10, v10, v48
  v_sub_f32 v11, v11, v48
  v_mul_f32 v8, s36, v8
  v_mul_f32 v9, s36, v9
  v_mul_f32 v10, s36, v10
  v_mul_f32 v11, s36, v11
  v_exp_f32 v8, v8
  v_exp_f32 v9, v9
  v_exp_f32 v10, v10
  v_exp_f32 v11, v11
  s_nop 0
  v_mul_f32 v48, v8, v12
  v_fmac_f32 v48, v9, v13
  v_fmac_f32 v48, v10, v14
  v_fmac_f32 v48, v11, v15
  v_rcp_f32 v48, v48
  s_nop 0
  v_mul_f32 v8, v8, v48
  v_mul_f32 v9, v9, v48
  v_mul_f32 v10, v10, v48
  v_mul_f32 v11, v11, v48
  s_waitcnt lgkmcnt(0)
  v_mul_f32 v16, v8, v16
  v_mul_f32 v17, v8, v17
  v_mul_f32 v18, v8, v18
  v_mul_f32 v19, v8, v19
  v_mul_f32 v20, v8, v20
  v_mul_f32 v21, v8, v21
  v_mul_f32 v22, v8, v22
  v_mul_f32 v23, v8, v23
  v_fmac_f32 v16, v9, v24
  v_fmac_f32 v17, v9, v25
  v_fmac_f32 v18, v9, v26
  v_fmac_f32 v19, v9, v27
  v_fmac_f32 v20, v9, v28
  v_fmac_f32 v21, v9, v29
  v_fmac_f32 v22, v9, v30
  v_fmac_f32 v23, v9, v31
  v_fmac_f32 v16, v10, v32
  v_fmac_f32 v17, v10, v33
  v_fmac_f32 v18, v10, v34
  v_fmac_f32 v19, v10, v35
  v_fmac_f32 v20, v10, v36
  v_fmac_f32 v21, v10, v37
  v_fmac_f32 v22, v10, v38
  v_fmac_f32 v23, v10, v39
  v_fmac_f32 v16, v11, v40
  v_fmac_f32 v17, v11, v41
  v_fmac_f32 v18, v11, v42
  v_fmac_f32 v19, v11, v43
  v_fmac_f32 v20, v11, v44
  v_fmac_f32 v21, v11, v45
  v_fmac_f32 v22, v11, v46
  v_fmac_f32 v23, v11, v47
  v_cvt_pk_bf16_f32 v48, v16, v17
  v_cvt_pk_bf16_f32 v49, v18, v19
  v_cvt_pk_bf16_f32 v50, v20, v21
  v_cvt_pk_bf16_f32 v51, v22, v23
  ds_write2_b32 v55, v48, v50 offset1:16
  v_add_u32 v55, 4352, v55
  ds_write2_b32 v55, v49, v51 offset1:16
  v_mov_b32 v12, 0
  v_mov_b32 v13, 0
  v_mov_b32 v14, 0
  v_mov_b32 v15, 0
  v_mov_b32 v16, 0
  v_mov_b32 v17, 0
  v_mov_b32 v18, 0
  v_mov_b32 v19, 0
  v_mov_b32 v20, 0
  v_mov_b32 v21, 0
  v_mov_b32 v22, 0
  v_mov_b32 v23, 0
  v_mov_b32 v24, 0
  v_mov_b32 v25, 0
  v_mov_b32 v26, 0
  v_mov_b32 v27, 0
  v_mov_b32 v28, 0
  v_mov_b32 v29, 0
  v_mov_b32 v30, 0
  v_mov_b32 v31, 0
  v_mov_b32 v32, 0
  v_mov_b32 v33, 0
  v_mov_b32 v34, 0
  v_mov_b32 v35, 0
  v_mov_b32 v36, 0
  v_mov_b32 v37, 0
  v_mov_b32 v38, 0
  v_mov_b32 v39, 0
  v_mov_b32 v40, 0
  v_mov_b32 v41, 0
  v_mov_b32 v42, 0
  v_mov_b32 v43, 0
  s_waitcnt lgkmcnt(0)
  s_barrier
  ds_read_b128 v[44:47], v253
  ds_read_b128 v[48:51], v253 offset:64
  s_waitcnt lgkmcnt(1)
  v_smfmac_f32_16x16x64_bf16 v[12:15], v[44:47], v[56:63], v255
  v_smfmac_f32_16x16x64_bf16 v[16:19], v[44:47], v[64:71], v255
  v_smfmac_f32_16x16x64_bf16 v[20:23], v[44:47], v[72:79], v255
  v_smfmac_f32_16x16x64_bf16 v[24:27], v[44:47], v[80:87], v255
  v_smfmac_f32_16x16x64_bf16 v[28:31], v[44:47], v[88:95], v255
  v_smfmac_f32_16x16x64_bf16 v[32:35], v[44:47], v[96:103], v255
  v_smfmac_f32_16x16x64_bf16 v[36:39], v[44:47], v[104:111], v255
  v_smfmac_f32_16x16x64_bf16 v[40:43], v[44:47], v[112:119], v255
  s_mov_b32 s34, 458752
  buffer_load_dwordx4 v[56:59], v252, s[44:47], s34 offen offset:0
  s_mov_b32 s34, 458752
  buffer_load_dwordx4 v[60:63], v252, s[44:47], s34 offen offset:1024
  s_mov_b32 s34, 458752
  buffer_load_dwordx4 v[64:67], v252, s[44:47], s34 offen offset:2048
  s_mov_b32 s34, 458752
  buffer_load_dwordx4 v[68:71], v252, s[44:47], s34 offen offset:3072
  s_mov_b32 s34, 462848
  buffer_load_dwordx4 v[72:75], v252, s[44:47], s34 offen offset:0
  s_mov_b32 s34, 462848
  buffer_load_dwordx4 v[76:79], v252, s[44:47], s34 offen offset:1024
  s_mov_b32 s34, 462848
  buffer_load_dwordx4 v[80:83], v252, s[44:47], s34 offen offset:2048
  s_mov_b32 s34, 462848
  buffer_load_dwordx4 v[84:87], v252, s[44:47], s34 offen offset:3072
  s_mov_b32 s34, 491520
  buffer_load_dwordx4 v[88:91], v252, s[44:47], s34 offen offset:0
  s_mov_b32 s34, 491520
  buffer_load_dwordx4 v[92:95], v252, s[44:47], s34 offen offset:1024
  s_mov_b32 s34, 491520
  buffer_load_dwordx4 v[96:99], v252, s[44:47], s34 offen offset:2048
  s_mov_b32 s34, 491520
  buffer_load_dwordx4 v[100:103], v252, s[44:47], s34 offen offset:3072
  s_mov_b32 s34, 495616
  buffer_load_dwordx4 v[104:107], v252, s[44:47], s34 offen offset:0
  s_mov_b32 s34, 495616
  buffer_load_dwordx4 v[108:111], v252, s[44:47], s34 offen offset:1024
  s_mov_b32 s34, 495616
  buffer_load_dwordx4 v[112:115], v252, s[44:47], s34 offen offset:2048
  s_mov_b32 s34, 495616
  buffer_load_dwordx4 v[116:119], v252, s[44:47], s34 offen offset:3072
  ds_read_b128 v[44:47], v253 offset:128
  s_waitcnt lgkmcnt(1)
  v_smfmac_f32_16x16x64_bf16 v[12:15], v[48:51], v[120:127], v255
  v_smfmac_f32_16x16x64_bf16 v[16:19], v[48:51], v[128:135], v255
  v_smfmac_f32_16x16x64_bf16 v[20:23], v[48:51], v[136:143], v255
  v_smfmac_f32_16x16x64_bf16 v[24:27], v[48:51], v[144:151], v255
  v_smfmac_f32_16x16x64_bf16 v[28:31], v[48:51], v[152:159], v255
  v_smfmac_f32_16x16x64_bf16 v[32:35], v[48:51], v[160:167], v255
  v_smfmac_f32_16x16x64_bf16 v[36:39], v[48:51], v[168:175], v255
  v_smfmac_f32_16x16x64_bf16 v[40:43], v[48:51], v[176:183], v255
  ds_read_b128 v[48:51], v253 offset:448
  s_waitcnt lgkmcnt(1)
  v_smfmac_f32_16x16x64_bf16 v[12:15], v[44:47], v[184:191], v255
  v_smfmac_f32_16x16x64_bf16 v[16:19], v[44:47], v[192:199], v255
  v_smfmac_f32_16x16x64_bf16 v[20:23], v[44:47], v[200:207], v255
  v_smfmac_f32_16x16x64_bf16 v[24:27], v[44:47], v[208:215], v255
  v_smfmac_f32_16x16x64_bf16 v[28:31], v[44:47], v[216:223], v255
  v_smfmac_f32_16x16x64_bf16 v[32:35], v[44:47], v[224:231], v255
  v_smfmac_f32_16x16x64_bf16 v[36:39], v[44:47], v[232:239], v255
  v_smfmac_f32_16x16x64_bf16 v[40:43], v[44:47], v[240:247], v255
  s_waitcnt vmcnt(0) lgkmcnt(0)
  v_perm_b32 v120, v60, v56, s40
  v_perm_b32 v121, v68, v64, s40
  v_perm_b32 v122, v76, v72, s40
  v_perm_b32 v123, v84, v80, s40
  v_perm_b32 v124, v92, v88, s40
  v_perm_b32 v125, v100, v96, s40
  v_perm_b32 v126, v108, v104, s40
  v_perm_b32 v127, v116, v112, s40
  v_perm_b32 v128, v60, v56, s41
  v_perm_b32 v129, v68, v64, s41
  v_perm_b32 v130, v76, v72, s41
  v_perm_b32 v131, v84, v80, s41
  v_perm_b32 v132, v92, v88, s41
  v_perm_b32 v133, v100, v96, s41
  v_perm_b32 v134, v108, v104, s41
  v_perm_b32 v135, v116, v112, s41
  v_smfmac_f32_16x16x64_bf16 v[12:15], v[48:51], v[120:127], v255
  v_perm_b32 v120, v61, v57, s40
  v_perm_b32 v121, v69, v65, s40
  v_perm_b32 v122, v77, v73, s40
  v_perm_b32 v123, v85, v81, s40
  v_perm_b32 v124, v93, v89, s40
  v_perm_b32 v125, v101, v97, s40
  v_perm_b32 v126, v109, v105, s40
  v_perm_b32 v127, v117, v113, s40
  v_smfmac_f32_16x16x64_bf16 v[16:19], v[48:51], v[128:135], v255
  v_perm_b32 v128, v61, v57, s41
  v_perm_b32 v129, v69, v65, s41
  v_perm_b32 v130, v77, v73, s41
  v_perm_b32 v131, v85, v81, s41
  v_perm_b32 v132, v93, v89, s41
  v_perm_b32 v133, v101, v97, s41
  v_perm_b32 v134, v109, v105, s41
  v_perm_b32 v135, v117, v113, s41
  v_smfmac_f32_16x16x64_bf16 v[20:23], v[48:51], v[120:127], v255
  v_perm_b32 v120, v62, v58, s40
  v_perm_b32 v121, v70, v66, s40
  v_perm_b32 v122, v78, v74, s40
  v_perm_b32 v123, v86, v82, s40
  v_perm_b32 v124, v94, v90, s40
  v_perm_b32 v125, v102, v98, s40
  v_perm_b32 v126, v110, v106, s40
  v_perm_b32 v127, v118, v114, s40
  v_smfmac_f32_16x16x64_bf16 v[24:27], v[48:51], v[128:135], v255
  v_perm_b32 v128, v62, v58, s41
  v_perm_b32 v129, v70, v66, s41
  v_perm_b32 v130, v78, v74, s41
  v_perm_b32 v131, v86, v82, s41
  v_perm_b32 v132, v94, v90, s41
  v_perm_b32 v133, v102, v98, s41
  v_perm_b32 v134, v110, v106, s41
  v_perm_b32 v135, v118, v114, s41
  v_smfmac_f32_16x16x64_bf16 v[28:31], v[48:51], v[120:127], v255
  v_perm_b32 v120, v63, v59, s40
  v_perm_b32 v121, v71, v67, s40
  v_perm_b32 v122, v79, v75, s40
  v_perm_b32 v123, v87, v83, s40
  v_perm_b32 v124, v95, v91, s40
  v_perm_b32 v125, v103, v99, s40
  v_perm_b32 v126, v111, v107, s40
  v_perm_b32 v127, v119, v115, s40
  v_smfmac_f32_16x16x64_bf16 v[32:35], v[48:51], v[128:135], v255
  v_perm_b32 v128, v63, v59, s41
  v_perm_b32 v129, v71, v67, s41
  v_perm_b32 v130, v79, v75, s41
  v_perm_b32 v131, v87, v83, s41
  v_perm_b32 v132, v95, v91, s41
  v_perm_b32 v133, v103, v99, s41
  v_perm_b32 v134, v111, v107, s41
  v_perm_b32 v135, v119, v115, s41
  v_smfmac_f32_16x16x64_bf16 v[36:39], v[48:51], v[120:127], v255
  s_nop 0
  v_smfmac_f32_16x16x64_bf16 v[40:43], v[48:51], v[128:135], v255
  v_and_b32 v2, 15, v0
  v_lshrrev_b32 v3, 4, v0
  v_and_b32 v3, 1, v3
  v_lshrrev_b32 v5, 5, v0
  v_lshrrev_b32 v4, 3, v2
  v_lshlrev_b32 v4, 14, v4
  v_lshlrev_b32 v6, 9, v3
  v_add_u32 v4, v4, v6
  v_lshlrev_b32 v6, 8, v5
  v_add_u32 v4, v4, v6
  v_and_b32 v6, 7, v2
  v_lshlrev_b32 v6, 4, v6
  v_add_u32 v4, v4, v6
  s_lshl_b32 s34, s22, 3
  s_lshl_b32 s38, s23, 1
  s_add_u32 s34, s34, s38
  s_lshl_b32 s34, s34, 14
  s_lshl_b32 s38, s21, 11
  s_add_u32 s34, s34, s38
  s_add_u32 s34, s34, 4194304
  s_add_u32 s58, s18, s34
  s_addc_u32 s59, s19, 0
  s_lshl_b32 s34, s23, 15
  v_lshlrev_b32 v1, 4, v0
  v_add_u32 v1, s34, v1
  v_mov_b32 v187, s62
  v_mov_b32 v191, s62
  v_mov_b32 v195, s62
  v_mov_b32 v199, s62
  v_lshrrev_b32 v8, 4, v0
  v_and_b32 v8, 1, v8
  v_lshrrev_b32 v9, 3, v0
  v_and_b32 v9, 1, v9
  v_and_b32 v10, 7, v0
  v_lshrrev_b32 v7, 5, v0
  v_lshlrev_b32 v11, 10, v8
  v_lshlrev_b32 v6, 7, v9
  v_add_u32 v11, v11, v6
  v_lshlrev_b32 v6, 4, v10
  v_add_u32 v11, v11, v6
  v_lshlrev_b32 v6, 11, v7
  v_add_u32 v11, v11, v6
  v_add_u32 v209, 4096, v11
  v_add_u32 v210, 8192, v11
  v_add_u32 v211, 12288, v11
  s_lshl_b32 s34, s2, 14
  s_lshl_b32 s38, s23, 8
  s_add_u32 s34, s34, s38
  s_add_u32 s34, s34, 4194304
  s_add_u32 s56, s18, s34
  s_addc_u32 s57, s19, 0
  s_lshl_b32 s34, s22, 3
  s_lshl_b32 s38, s23, 1
  s_add_u32 s34, s34, s38
  s_lshl_b32 s34, s34, 10
  s_lshl_b32 s38, s21, 7
  s_add_u32 s34, s34, s38
  v_lshlrev_b32 v212, 10, v9
  v_lshlrev_b32 v6, 4, v10
  v_add_u32 v212, v212, v6
  v_lshlrev_b32 v6, 3, v8
  v_add_u32 v212, v212, v6
  v_add_u32 v212, s34, v212
  s_mov_b32 s54, 0xffff0000
  s_barrier
  ds_read_b128 v[120:123], v1 offset:16384
  ds_read_b128 v[124:127], v1 offset:17408
  ds_read_b128 v[128:131], v1 offset:18432
  ds_read_b128 v[132:135], v1 offset:19456
  ds_read_b128 v[136:139], v1 offset:20480
  ds_read_b128 v[140:143], v1 offset:21504
  ds_read_b128 v[144:147], v1 offset:22528
  ds_read_b128 v[148:151], v1 offset:23552
  s_waitcnt lgkmcnt(4)
  v_add_f32 v152, v12, v120
  v_add_f32 v160, v13, v121
  v_add_f32 v168, v14, v122
  v_add_f32 v176, v15, v123
  v_add_f32 v153, v16, v124
  v_add_f32 v161, v17, v125
  v_add_f32 v169, v18, v126
  v_add_f32 v177, v19, v127
  v_add_f32 v154, v20, v128
  v_add_f32 v162, v21, v129
  v_add_f32 v170, v22, v130
  v_add_f32 v178, v23, v131
  v_add_f32 v155, v24, v132
  v_add_f32 v163, v25, v133
  v_add_f32 v171, v26, v134
  v_add_f32 v179, v27, v135
  s_nop 0
  v_permlane32_swap_b32 v152, v168
  v_permlane32_swap_b32 v153, v169
  v_permlane32_swap_b32 v154, v170
  v_permlane32_swap_b32 v155, v171
  v_permlane32_swap_b32 v160, v176
  v_permlane32_swap_b32 v161, v177
  v_permlane32_swap_b32 v162, v178
  v_permlane32_swap_b32 v163, v179
  v_add_f32 v152, v152, v168
  v_add_f32 v153, v153, v169
  v_add_f32 v154, v154, v170
  v_add_f32 v155, v155, v171
  v_add_f32 v160, v160, v176
  v_add_f32 v161, v161, v177
  v_add_f32 v162, v162, v178
  v_add_f32 v163, v163, v179
  v_cvt_pk_bf16_f32 v184, v152, v153
  v_cvt_pk_bf16_f32 v185, v154, v155
  v_cvt_pk_bf16_f32 v192, v160, v161
  v_cvt_pk_bf16_f32 v193, v162, v163
  s_waitcnt lgkmcnt(0)
  v_add_f32 v156, v28, v136
  v_add_f32 v164, v29, v137
  v_add_f32 v172, v30, v138
  v_add_f32 v180, v31, v139
  v_add_f32 v157, v32, v140
  v_add_f32 v165, v33, v141
  v_add_f32 v173, v34, v142
  v_add_f32 v181, v35, v143
  v_add_f32 v158, v36, v144
  v_add_f32 v166, v37, v145
  v_add_f32 v174, v38, v146
  v_add_f32 v182, v39, v147
  v_add_f32 v159, v40, v148
  v_add_f32 v167, v41, v149
  v_add_f32 v175, v42, v150
  v_add_f32 v183, v43, v151
  s_nop 0
  v_permlane32_swap_b32 v156, v172
  v_permlane32_swap_b32 v157, v173
  v_permlane32_swap_b32 v158, v174
  v_permlane32_swap_b32 v159, v175
  v_permlane32_swap_b32 v164, v180
  v_permlane32_swap_b32 v165, v181
  v_permlane32_swap_b32 v166, v182
  v_permlane32_swap_b32 v167, v183
  v_add_f32 v156, v156, v172
  v_add_f32 v157, v157, v173
  v_add_f32 v158, v158, v174
  v_add_f32 v159, v159, v175
  v_add_f32 v164, v164, v180
  v_add_f32 v165, v165, v181
  v_add_f32 v166, v166, v182
  v_add_f32 v167, v167, v183
  v_cvt_pk_bf16_f32 v188, v156, v157
  v_cvt_pk_bf16_f32 v189, v158, v159
  v_cvt_pk_bf16_f32 v196, v164, v165
  v_cvt_pk_bf16_f32 v197, v166, v167
  v_xor_b32 v186, v184, v185
  v_xor_b32 v186, s61, v186
  global_store_dwordx4 v4, v[184:187], s[58:59] offset:0 sc1
  v_xor_b32 v190, v188, v189
  v_xor_b32 v190, s61, v190
  global_store_dwordx4 v4, v[188:191], s[58:59] offset:1024 sc1
  v_xor_b32 v194, v192, v193
  v_xor_b32 v194, s61, v194
  global_store_dwordx4 v4, v[192:195], s[58:59] offset:128 sc1
  v_xor_b32 v198, v196, v197
  v_xor_b32 v198, s61, v198
  global_store_dwordx4 v4, v[196:199], s[58:59] offset:1152 sc1
  s_mov_b32 s55, 200000
  global_load_dwordx4 v[12:15], v11, s[56:57] sc1
  global_load_dwordx4 v[16:19], v209, s[56:57] sc1
  global_load_dwordx4 v[20:23], v210, s[56:57] sc1
  global_load_dwordx4 v[24:27], v211, s[56:57] sc1
  global_load_dwordx4 v[216:219], v11, s[56:57] sc1
  global_load_dwordx4 v[220:223], v209, s[56:57] sc1
  global_load_dwordx4 v[224:227], v210, s[56:57] sc1
  global_load_dwordx4 v[228:231], v211, s[56:57] sc1
L_rpoll_13:
  s_waitcnt vmcnt(4)
  v_xor_b32 v45, v12, v13
  v_xor_b32 v45, v45, v14
  v_xor_b32 v45, v45, v15
  v_xor_b32 v45, 0x9e3779b9, v45
  v_subrev_u32 v46, s60, v15
  v_lshrrev_b32 v46, 12, v46
  v_or_b32 v44, v45, v46
  v_xor_b32 v45, v16, v17
  v_xor_b32 v45, v45, v18
  v_xor_b32 v45, v45, v19
  v_xor_b32 v45, 0x9e3779b9, v45
  v_subrev_u32 v46, s60, v19
  v_lshrrev_b32 v46, 12, v46
  v_or3_b32 v44, v44, v45, v46
  v_xor_b32 v45, v20, v21
  v_xor_b32 v45, v45, v22
  v_xor_b32 v45, v45, v23
  v_xor_b32 v45, 0x9e3779b9, v45
  v_subrev_u32 v46, s60, v23
  v_lshrrev_b32 v46, 12, v46
  v_or3_b32 v44, v44, v45, v46
  v_xor_b32 v45, v24, v25
  v_xor_b32 v45, v45, v26
  v_xor_b32 v45, v45, v27
  v_xor_b32 v45, 0x9e3779b9, v45
  v_subrev_u32 v46, s60, v27
  v_lshrrev_b32 v46, 12, v46
  v_or3_b32 v44, v44, v45, v46
  v_cmp_ne_u32 vcc, 0, v44
  s_cbranch_vccz L_rdone_14
  global_load_dwordx4 v[12:15], v11, s[56:57] sc1
  global_load_dwordx4 v[16:19], v209, s[56:57] sc1
  global_load_dwordx4 v[20:23], v210, s[56:57] sc1
  global_load_dwordx4 v[24:27], v211, s[56:57] sc1
  s_waitcnt vmcnt(4)
  v_xor_b32 v45, v216, v217
  v_xor_b32 v45, v45, v218
  v_xor_b32 v45, v45, v219
  v_xor_b32 v45, 0x9e3779b9, v45
  v_subrev_u32 v46, s60, v219
  v_lshrrev_b32 v46, 12, v46
  v_or_b32 v44, v45, v46
  v_xor_b32 v45, v220, v221
  v_xor_b32 v45, v45, v222
  v_xor_b32 v45, v45, v223
  v_xor_b32 v45, 0x9e3779b9, v45
  v_subrev_u32 v46, s60, v223
  v_lshrrev_b32 v46, 12, v46
  v_or3_b32 v44, v44, v45, v46
  v_xor_b32 v45, v224, v225
  v_xor_b32 v45, v45, v226
  v_xor_b32 v45, v45, v227
  v_xor_b32 v45, 0x9e3779b9, v45
  v_subrev_u32 v46, s60, v227
  v_lshrrev_b32 v46, 12, v46
  v_or3_b32 v44, v44, v45, v46
  v_xor_b32 v45, v228, v229
  v_xor_b32 v45, v45, v230
  v_xor_b32 v45, v45, v231
  v_xor_b32 v45, 0x9e3779b9, v45
  v_subrev_u32 v46, s60, v231
  v_lshrrev_b32 v46, 12, v46
  v_or3_b32 v44, v44, v45, v46
  v_cmp_ne_u32 vcc, 0, v44
  s_cbranch_vccz L_rgotb_15
  global_load_dwordx4 v[216:219], v11, s[56:57] sc1
  global_load_dwordx4 v[220:223], v209, s[56:57] sc1
  global_load_dwordx4 v[224:227], v210, s[56:57] sc1
  global_load_dwordx4 v[228:231], v211, s[56:57] sc1
  s_sub_u32 s55, s55, 1
  s_cmp_eq_u32 s55, 0
  s_cbranch_scc0 L_rpoll_13
  s_waitcnt vmcnt(0)
  s_branch L_rdone_14
L_rgotb_15:
  v_lshlrev_b32 v28, 16, v216
  v_and_b32 v29, s54, v216
  v_lshlrev_b32 v30, 16, v217
  v_and_b32 v31, s54, v217
  v_lshlrev_b32 v32, 16, v220
  v_and_b32 v33, s54, v220
  v_lshlrev_b32 v34, 16, v221
  v_and_b32 v35, s54, v221
  v_add_f32 v28, v28, v32
  v_add_f32 v29, v29, v33
  v_add_f32 v30, v30, v34
  v_add_f32 v31, v31, v35
  v_lshlrev_b32 v32, 16, v224
  v_and_b32 v33, s54, v224
  v_lshlrev_b32 v34, 16, v225
  v_and_b32 v35, s54, v225
  v_add_f32 v28, v28, v32
  v_add_f32 v29, v29, v33
  v_add_f32 v30, v30, v34
  v_add_f32 v31, v31, v35
  v_lshlrev_b32 v32, 16, v228
  v_and_b32 v33, s54, v228
  v_lshlrev_b32 v34, 16, v229
  v_and_b32 v35, s54, v229
  v_add_f32 v28, v28, v32
  v_add_f32 v29, v29, v33
  v_add_f32 v30, v30, v34
  v_add_f32 v31, v31, v35
  v_mov_b32 v32, v28
  v_mov_b32 v33, v29
  v_mov_b32 v34, v30
  v_mov_b32 v35, v31
  s_nop 1
  v_permlane32_swap_b32 v28, v32
  v_permlane32_swap_b32 v29, v33
  v_permlane32_swap_b32 v30, v34
  v_permlane32_swap_b32 v31, v35
  s_nop 0
  v_add_f32 v28, v28, v32
  v_add_f32 v29, v29, v33
  v_add_f32 v30, v30, v34
  v_add_f32 v31, v31, v35
  v_cvt_pk_bf16_f32 v28, v28, v29
  v_cvt_pk_bf16_f32 v29, v30, v31
  s_mov_b32 exec_lo, -1
  s_mov_b32 exec_hi, 0
  global_store_dwordx2 v212, v[28:29], s[14:15]
  s_mov_b64 exec, -1
  s_branch L_fin
L_rdone_14:
  v_lshlrev_b32 v28, 16, v12
  v_and_b32 v29, s54, v12
  v_lshlrev_b32 v30, 16, v13
  v_and_b32 v31, s54, v13
  v_lshlrev_b32 v32, 16, v16
  v_and_b32 v33, s54, v16
  v_lshlrev_b32 v34, 16, v17
  v_and_b32 v35, s54, v17
  v_add_f32 v28, v28, v32
  v_add_f32 v29, v29, v33
  v_add_f32 v30, v30, v34
  v_add_f32 v31, v31, v35
  v_lshlrev_b32 v32, 16, v20
  v_and_b32 v33, s54, v20
  v_lshlrev_b32 v34, 16, v21
  v_and_b32 v35, s54, v21
  v_add_f32 v28, v28, v32
  v_add_f32 v29, v29, v33
  v_add_f32 v30, v30, v34
  v_add_f32 v31, v31, v35
  v_lshlrev_b32 v32, 16, v24
  v_and_b32 v33, s54, v24
  v_lshlrev_b32 v34, 16, v25
  v_and_b32 v35, s54, v25
  v_add_f32 v28, v28, v32
  v_add_f32 v29, v29, v33
  v_add_f32 v30, v30, v34
  v_add_f32 v31, v31, v35
  v_mov_b32 v32, v28
  v_mov_b32 v33, v29
  v_mov_b32 v34, v30
  v_mov_b32 v35, v31
  s_nop 1
  v_permlane32_swap_b32 v28, v32
  v_permlane32_swap_b32 v29, v33
  v_permlane32_swap_b32 v30, v34
  v_permlane32_swap_b32 v31, v35
  s_nop 0
  v_add_f32 v28, v28, v32
  v_add_f32 v29, v29, v33
  v_add_f32 v30, v30, v34
  v_add_f32 v31, v31, v35
  v_cvt_pk_bf16_f32 v28, v28, v29
  v_cvt_pk_bf16_f32 v29, v30, v31
  s_mov_b32 exec_lo, -1
  s_mov_b32 exec_hi, 0
  global_store_dwordx2 v212, v[28:29], s[14:15]
  s_mov_b64 exec, -1
L_fin:
L_end:
  s_endpgm
.section .rodata,"a"
.p2align 6
.amdhsa_kernel standalone__gqa_block_cached__sampling_kernel
  .amdhsa_next_free_vgpr 256
  .amdhsa_next_free_sgpr 96
  .amdhsa_accum_offset 256
  .amdhsa_group_segment_fixed_size 0
  .amdhsa_kernarg_size 64
  .amdhsa_user_sgpr_count 2
  .amdhsa_user_sgpr_kernarg_segment_ptr 1
  .amdhsa_system_sgpr_workgroup_id_x 1
.end_amdhsa_kernel
```
